```python
import torch

def _softmax(x, axis=-1):
    return torch.softmax(x, dim=axis)
def _gelu(x):
    return torch.nn.functional.gelu(x, approximate="tanh")
def _silu(x):
    return torch.nn.functional.silu(x)
def _sigmoid(x):
    return torch.sigmoid(x)
def _layernorm(x, axis=-1, eps=1e-5):
    m = x.mean(dim=axis, keepdim=True)
    v = x.var(dim=axis, keepdim=True, unbiased=False)
    return (x - m) / torch.sqrt(v + eps)
def _scatter_add(tgt, idx, src, axis=0):
    return tgt.clone().index_add_(axis, idx, src)
def _segment_sum(src, seg, n):
    out = torch.zeros((n,) + src.shape[1:], dtype=src.dtype)
    return out.index_add_(0, seg, src)
def _pad(x, pw):
    flat = tuple(v for pair in reversed(pw) for v in pair)
    return torch.nn.functional.pad(x, flat)

kernel_name = 'parallel_sum__grouped_kv_mqa__glu_gated_reglu__prompt'

def setup_inputs():

    _w = (lambda a: (lambda t: t.to(torch.bfloat16) if t.is_floating_point() else t)(torch.as_tensor(a)))
    def _A_setup():
        B, S, D, H = 1, 2048, 640, 32
        Dh = D // H
        return {
            "x": _w((lambda *s: torch.randn(*s, dtype=torch.bfloat16) * 0.05)(B, S, D)),
            "wq": _w((lambda *s: torch.randn(*s, dtype=torch.bfloat16) * 0.05)(D, H * Dh)),
            "wk": _w((lambda *s: torch.randn(*s, dtype=torch.bfloat16) * 0.05)(D, Dh)),
            "wv": _w((lambda *s: torch.randn(*s, dtype=torch.bfloat16) * 0.05)(D, Dh)),
            "wo": _w((lambda *s: torch.randn(*s, dtype=torch.bfloat16) * 0.05)(H * Dh, D)),
        }
    _A_in = _A_setup()

    def _B_setup():
        B, S, D, F = 1, 2048, 640, 1728
        return {
            "x": _w((lambda *s: torch.randn(*s, dtype=torch.bfloat16) * 0.05)(B, S, D)),
            "W_gate": _w((lambda *s: torch.randn(*s, dtype=torch.bfloat16) * 0.8)(D, F) * (2.0 / D) ** 0.5),
            "W_up": _w((lambda *s: torch.randn(*s, dtype=torch.bfloat16) * 0.8)(D, F) * (2.0 / D) ** 0.5),
            "W_down": _w((lambda *s: torch.randn(*s, dtype=torch.bfloat16) * 0.8)(F, D) * (1.0 / F) ** 0.5),
        }
    _B_in = _B_setup()

    return {
        "A_x": _A_in["x"],
        "A_wq": _A_in["wq"],
        "A_wk": _A_in["wk"],
        "A_wv": _A_in["wv"],
        "A_wo": _A_in["wo"],
        "B_x": _B_in["x"],
        "B_W_gate": _B_in["W_gate"],
        "B_W_up": _B_in["W_up"],
        "B_W_down": _B_in["W_down"],
    }

def reference(A_x, A_wq, A_wk, A_wv, A_wo, B_x, B_W_gate, B_W_up, B_W_down):
    def _A_ref(x, wq, wk, wv, wo):
        B, S, D = x.shape
        H = 32
        Dh = D // H
        q = (lambda x, *d: x.permute(*d))((x @ wq).reshape(B, S, H, Dh), 0, 2, 1, 3)
        k = x @ wk
        v = x @ wv
        scores = torch.einsum("bhqd,bkd->bhqk", q, k) * (Dh ** -0.5)
        p = _softmax(scores, axis=-1)
        o = torch.einsum("bhqk,bkd->bhqd", p, v)
        return (lambda x, *d: x.permute(*d))(o, 0, 2, 1, 3).reshape(B, S, H * Dh) @ wo

    def _B_ref(x, W_gate, W_up, W_down):
        gate = torch.einsum("bsd,df->bsf", x, W_gate)
        up = torch.einsum("bsd,df->bsf", x, W_up)
        gate = gate * (lambda x, dt: x.to(dt))(gate > 0, gate.dtype)
        h = gate * up
        return torch.einsum("bsf,fd->bsd", h, W_down)

    x = A_x
    xn = _layernorm(x, axis=-1)
    return x + _A_ref(xn, A_wq, A_wk, A_wv, A_wo) + _B_ref(xn, B_W_gate, B_W_up, B_W_down)
```

```asm
; @launch grid=(256,1,1) block=(768,1,1) lds=163840
.amdgcn_target "amdgcn-amd-amdhsa--gfx950"
.text
.globl parallel_sum__grouped_kv_mqa__glu_gated_reglu__prompt_kernel
.p2align 8
.type parallel_sum__grouped_kv_mqa__glu_gated_reglu__prompt_kernel,@function
parallel_sum__grouped_kv_mqa__glu_gated_reglu__prompt_kernel:
    s_cmp_ge_u32 s2, 256
    s_cbranch_scc1 k2_end
    s_load_dwordx16 s[40:55], s[0:1], 0
    s_load_dwordx8 s[56:63], s[0:1], 64
    v_lshrrev_b32 v3, 6, v0
    s_nop 0
    v_readfirstlane_b32 s64, v3
    s_nop 0
    s_cmp_ge_u32 s64, 4
    s_cbranch_scc1 k1_compute
    v_and_b32 v1, 63, v0
    s_and_b32 s82, s2, 7
    s_lshr_b32 s83, s2, 3
    s_and_b32 s67, s82, 1
    s_lshl_b32 s67, s67, 2
    s_and_b32 s84, s83, 3
    s_or_b32 s67, s67, s84
    s_lshr_b32 s85, s82, 1
    s_lshr_b32 s84, s83, 2
    s_mul_i32 s68, s85, 7
    s_add_u32 s68, s68, s84
    s_cmp_eq_u32 s68, 6
    s_cselect_b32 s68, 31, s68
    s_min_u32 s86, s85, 1
    s_sub_u32 s68, s68, s86
    s_add_u32 s85, s85, 27
    s_cmp_eq_u32 s84, 7
    s_cselect_b32 s68, s85, s68
    s_and_b32 s65, s64, 3
    s_lshr_b32 s66, s64, 3
    v_lshlrev_b32 v2, 4, v1
    s_setprio 2
    s_cmp_lt_u32 s68, 27
    s_movk_i32 s69, 1280
    s_cselect_b32 s69, 3456, s69
    s_lshl_b32 s74, s69, 6
    v_lshrrev_b32 v16, 3, v1
    v_and_b32 v17, 7, v1
    v_lshrrev_b32 v18, 4, v1
    s_lshl_b32 s82, s65, 6
    v_add_u32 v19, s82, v16
    v_mul_u32_u24 v19, 1280, v19
    v_xor_b32 v20, v17, v18
    v_xor_b32 v21, 4, v20
    v_lshl_add_u32 v4, v20, 4, v19
    v_lshl_add_u32 v5, v21, 4, v19
    v_add_u32 v6, 18432, v4
    v_add_u32 v7, 27648, v5
    v_add_u32 v5, 9216, v5
    s_lshl_b32 s82, s65, 4
    v_add_u32 v19, s82, v16
    v_mul_u32_u24 v19, s69, v19
    v_and_b32 v20, 1, v18
    v_lshlrev_b32 v20, 2, v20
    v_xor_b32 v20, v17, v20
    v_lshl_add_u32 v8, v20, 4, v19
    s_lshl_b32 s82, s69, 3
    s_sub_u32 s82, s82, 1024
    v_xor_b32 v9, 0, v8
    v_add_u32 v9, s82, v9
    s_mul_i32 s82, s65, 640
    v_add_u32 v10, s82, v2
    s_lshl_b32 s75, s65, 13
    s_lshl_b32 s76, s65, 11
    s_add_u32 s76, s76, 32768
    s_add_u32 s77, s82, 49152
    s_mov_b32 s70, 0
    s_mov_b32 s71, 40960
    s_mov_b32 s72, 0
    s_mov_b32 s73, 0
    s_mul_i32 s85, s67, 327680
    s_lshl_b32 s82, s68, 7
    s_sub_u32 s86, s68, 27
    s_lshl_b32 s83, s86, 8
    s_add_u32 s84, s83, 128
    s_cmp_lt_u32 s68, 27
    s_cselect_b32 s83, s82, s83
    s_cselect_b32 s84, s82, s84
    s_mul_i32 s10, s69, 639
    s_add_u32 s10, s10, 128
    s_mov_b32 s14, s10
    s_mov_b32 s6, 327680
    s_mov_b32 s7, 0x20000
    s_mov_b32 s11, 0x20000
    s_mov_b32 s15, 0x20000
    s_mov_b32 s19, 0x20000
    s_cmp_lt_u32 s68, 16
    s_cselect_b32 s18, 25600, 0
    s_waitcnt lgkmcnt(0)
    s_add_u32 s4, s40, s85
    s_addc_u32 s5, s41, 0
    s_cmp_lt_u32 s68, 27
    s_cselect_b32 s8, s52, s42
    s_cselect_b32 s9, s53, s43
    s_cselect_b32 s12, s54, s42
    s_cselect_b32 s13, s55, s43
    s_add_u32 s8, s8, s83
    s_addc_u32 s9, s9, 0
    s_add_u32 s12, s12, s84
    s_addc_u32 s13, s13, 0
    s_bitcmp0_b32 s68, 0
    s_cselect_b32 s16, s44, s46
    s_cselect_b32 s17, s45, s47
    v_lshlrev_b32 v12, 2, v1
    s_bfe_u32 s37, s2, 65540
    s_bfe_u32 s36, s2, 65540
    s_xor_b32 s82, s37, 0
    s_lshl_b32 s70, s82, 7
    s_add_u32 s71, s70, 40960
    s_mul_i32 s72, s82, s74
    s_bfe_u32 s82, s2, 196611
    s_cmp_eq_u32 s82, 1
    s_cbranch_scc1 k1_r1
    s_cmp_eq_u32 s82, 2
    s_cbranch_scc1 k1_r2
    s_cmp_eq_u32 s82, 0
    s_cbranch_scc1 k1_rx
    s_mov_b64 s[34:35], s[44:45]
    s_cmp_eq_u32 s82, 4
    s_cselect_b64 s[34:35], s[46:47], s[34:35]
    s_cmp_eq_u32 s82, 5
    s_cselect_b64 s[34:35], s[62:63], s[34:35]
    s_cmp_eq_u32 s82, 6
    s_cselect_b64 s[34:35], s[60:61], s[34:35]
    s_cmp_eq_u32 s82, 7
    s_cselect_b64 s[34:35], s[56:57], s[34:35]
    s_bfe_u32 s82, s2, 0x40003
    s_cmp_eq_u32 s82, 15
    s_cselect_b64 s[34:35], s[48:49], s[34:35]
    v_mov_b32 v14, 0
    s_mov_b64 exec, 1
    global_load_dword v14, v14, s[34:35]
    s_mov_b64 exec, -1
k1_rx:
    s_add_u32 m0, s75, 0
    s_nop 0
    buffer_load_dwordx4 v4, s[4:7], s70 offen offset:0 lds
    buffer_load_dwordx4 v5, s[4:7], s70 offen offset:1024 lds
    buffer_load_dwordx4 v6, s[4:7], s70 offen offset:2048 lds
    buffer_load_dwordx4 v7, s[4:7], s70 offen offset:3072 lds
    s_add_u32 m0, s75, 4096
    s_nop 0
    buffer_load_dwordx4 v4, s[4:7], s71 offen offset:0 lds
    buffer_load_dwordx4 v5, s[4:7], s71 offen offset:1024 lds
    buffer_load_dwordx4 v6, s[4:7], s71 offen offset:2048 lds
    buffer_load_dwordx4 v7, s[4:7], s71 offen offset:3072 lds
    s_add_u32 m0, s76, 0
    s_nop 0
    buffer_load_dwordx4 v8, s[8:11], s72 offen offset:0 lds
    buffer_load_dwordx4 v9, s[8:11], s72 offen offset:1024 lds
    s_add_u32 m0, s76, 8192
    s_nop 0
    buffer_load_dwordx4 v8, s[12:15], s72 offen offset:0 lds
    buffer_load_dwordx4 v9, s[12:15], s72 offen offset:1024 lds
    s_branch k1_r0
k1_r1:
    s_add_u32 m0, s76, 0
    s_nop 0
    buffer_load_dwordx4 v8, s[8:11], s72 offen offset:0 lds
    buffer_load_dwordx4 v9, s[8:11], s72 offen offset:1024 lds
    s_add_u32 m0, s76, 8192
    s_nop 0
    buffer_load_dwordx4 v8, s[12:15], s72 offen offset:0 lds
    buffer_load_dwordx4 v9, s[12:15], s72 offen offset:1024 lds
    s_add_u32 m0, s75, 0
    s_nop 0
    buffer_load_dwordx4 v4, s[4:7], s70 offen offset:0 lds
    buffer_load_dwordx4 v5, s[4:7], s70 offen offset:1024 lds
    buffer_load_dwordx4 v6, s[4:7], s70 offen offset:2048 lds
    buffer_load_dwordx4 v7, s[4:7], s70 offen offset:3072 lds
    s_add_u32 m0, s75, 4096
    s_nop 0
    buffer_load_dwordx4 v4, s[4:7], s71 offen offset:0 lds
    buffer_load_dwordx4 v5, s[4:7], s71 offen offset:1024 lds
    buffer_load_dwordx4 v6, s[4:7], s71 offen offset:2048 lds
    buffer_load_dwordx4 v7, s[4:7], s71 offen offset:3072 lds
    s_branch k1_r0
k1_r2:
    s_add_u32 m0, s76, 8192
    s_nop 0
    buffer_load_dwordx4 v8, s[12:15], s72 offen offset:0 lds
    buffer_load_dwordx4 v9, s[12:15], s72 offen offset:1024 lds
    s_add_u32 m0, s76, 0
    s_nop 0
    buffer_load_dwordx4 v8, s[8:11], s72 offen offset:0 lds
    buffer_load_dwordx4 v9, s[8:11], s72 offen offset:1024 lds
    s_add_u32 m0, s75, 0
    s_nop 0
    buffer_load_dwordx4 v4, s[4:7], s70 offen offset:0 lds
    buffer_load_dwordx4 v5, s[4:7], s70 offen offset:1024 lds
    buffer_load_dwordx4 v6, s[4:7], s70 offen offset:2048 lds
    buffer_load_dwordx4 v7, s[4:7], s70 offen offset:3072 lds
    s_add_u32 m0, s75, 4096
    s_nop 0
    buffer_load_dwordx4 v4, s[4:7], s71 offen offset:0 lds
    buffer_load_dwordx4 v5, s[4:7], s71 offen offset:1024 lds
    buffer_load_dwordx4 v6, s[4:7], s71 offen offset:2048 lds
    buffer_load_dwordx4 v7, s[4:7], s71 offen offset:3072 lds
k1_r0:
    s_add_u32 s70, s70, 128
    s_add_u32 s71, s71, 128
    s_add_u32 s72, s72, s74
    s_mov_b32 s20, s62
    s_mov_b32 s21, s63
    s_mov_b32 s22, 33554432
    s_mov_b32 s23, 0x20000
    s_mov_b32 s24, s60
    s_mov_b32 s25, s61
    s_mov_b32 s26, 256
    s_mov_b32 s27, 0x20000
    v_mov_b32 v11, 0xffff0000
    v_and_b32 v16, 31, v1
    v_lshrrev_b32 v17, 5, v1
    s_bfe_u32 s82, s68, 0x30001
    s_lshl_b32 s82, s82, 12
    v_lshlrev_b32 v20, 7, v16
    v_add_u32 v20, s82, v20
    v_bfe_u32 v21, v1, 1, 3
    v_xor_b32 v21, v21, v17
    s_lshl_b32 s82, s65, 1
    v_xor_b32 v21, s82, v21
    v_lshl_add_u32 v97, v21, 4, v20
    v_bfe_u32 v22, v1, 2, 2
    v_lshl_add_u32 v22, v17, 3, v22
    v_mul_u32_u24 v22, 40, v22
    v_bfe_u32 v21, v1, 4, 1
    v_lshl_add_u32 v22, v21, 5, v22
    v_and_b32 v21, 3, v1
    v_lshl_add_u32 v22, v21, 3, v22
    v_add_u32 v98, s77, v22
    v_add_u32 v99, 103424, v97
    v_add_u32 v100, 51712, v98
    v_mov_b32 v96, 0
    v_mov_b32 v80, 0
    v_mov_b32 v81, 0
    v_mov_b32 v82, 0
    v_mov_b32 v83, 0
    v_mov_b32 v84, 0
    v_mov_b32 v85, 0
    v_mov_b32 v86, 0
    v_mov_b32 v87, 0
    v_mov_b32 v88, 0
    v_mov_b32 v89, 0
    v_mov_b32 v90, 0
    v_mov_b32 v91, 0
    v_mov_b32 v92, 0
    v_mov_b32 v93, 0
    v_mov_b32 v94, 0
    v_mov_b32 v95, 0
    s_waitcnt vmcnt(0)
    s_cmp_ge_u32 s68, 16
    s_cbranch_scc1 k1_nokw
    s_mul_i32 s82, s65, 640
    s_lshl_b32 s83, s65, 13
    s_add_u32 m0, s83, 103424
    v_add_u32 v16, 0, v1
    v_mul_u32_u24 v17, 1639, v16
    v_lshrrev_b32 v17, 16, v17
    v_mul_u32_u24 v17, 1920, v17
    v_lshl_add_u32 v16, v16, 4, v17
    buffer_load_dwordx4 v16, s[16:19], s82 offen lds
    s_add_u32 m0, m0, 1024
    v_add_u32 v16, 64, v1
    v_mul_u32_u24 v17, 1639, v16
    v_lshrrev_b32 v17, 16, v17
    v_mul_u32_u24 v17, 1920, v17
    v_lshl_add_u32 v16, v16, 4, v17
    buffer_load_dwordx4 v16, s[16:19], s82 offen lds
    s_add_u32 m0, m0, 1024
    v_add_u32 v16, 128, v1
    v_mul_u32_u24 v17, 1639, v16
    v_lshrrev_b32 v17, 16, v17
    v_mul_u32_u24 v17, 1920, v17
    v_lshl_add_u32 v16, v16, 4, v17
    buffer_load_dwordx4 v16, s[16:19], s82 offen lds
    s_add_u32 m0, m0, 1024
    v_add_u32 v16, 192, v1
    v_mul_u32_u24 v17, 1639, v16
    v_lshrrev_b32 v17, 16, v17
    v_mul_u32_u24 v17, 1920, v17
    v_lshl_add_u32 v16, v16, 4, v17
    buffer_load_dwordx4 v16, s[16:19], s82 offen lds
    s_add_u32 m0, m0, 1024
    v_add_u32 v16, 256, v1
    v_mul_u32_u24 v17, 1639, v16
    v_lshrrev_b32 v17, 16, v17
    v_mul_u32_u24 v17, 1920, v17
    v_lshl_add_u32 v16, v16, 4, v17
    buffer_load_dwordx4 v16, s[16:19], s82 offen lds
    s_add_u32 m0, m0, 1024
    v_add_u32 v16, 320, v1
    v_mul_u32_u24 v17, 1639, v16
    v_lshrrev_b32 v17, 16, v17
    v_mul_u32_u24 v17, 1920, v17
    v_lshl_add_u32 v16, v16, 4, v17
    buffer_load_dwordx4 v16, s[16:19], s82 offen lds
    s_add_u32 m0, m0, 1024
    v_add_u32 v16, 384, v1
    v_mul_u32_u24 v17, 1639, v16
    v_lshrrev_b32 v17, 16, v17
    v_mul_u32_u24 v17, 1920, v17
    v_lshl_add_u32 v16, v16, 4, v17
    buffer_load_dwordx4 v16, s[16:19], s82 offen lds
    s_add_u32 m0, m0, 1024
k1_nokw:
    s_xor_b32 s82, s37, 1
    s_lshl_b32 s70, s82, 7
    s_add_u32 s71, s70, 40960
    s_mul_i32 s72, s82, s74
    s_add_u32 m0, s75, 51712
    s_nop 0
    buffer_load_dwordx4 v4, s[4:7], s70 offen offset:0 lds
    buffer_load_dwordx4 v5, s[4:7], s70 offen offset:1024 lds
    buffer_load_dwordx4 v6, s[4:7], s70 offen offset:2048 lds
    buffer_load_dwordx4 v7, s[4:7], s70 offen offset:3072 lds
    s_barrier
    ds_read_b128 v[72:75], v97 offset:0
    s_add_u32 m0, s75, 55808
    s_nop 0
    buffer_load_dwordx4 v4, s[4:7], s71 offen offset:0 lds
    buffer_load_dwordx4 v5, s[4:7], s71 offen offset:1024 lds
    buffer_load_dwordx4 v6, s[4:7], s71 offen offset:2048 lds
    buffer_load_dwordx4 v7, s[4:7], s71 offen offset:3072 lds
    s_add_u32 m0, s76, 51712
    s_nop 0
    buffer_load_dwordx4 v8, s[8:11], s72 offen offset:0 lds
    buffer_load_dwordx4 v9, s[8:11], s72 offen offset:1024 lds
    s_add_u32 m0, s76, 59904
    s_nop 0
    buffer_load_dwordx4 v8, s[12:15], s72 offen offset:0 lds
    buffer_load_dwordx4 v9, s[12:15], s72 offen offset:1024 lds
    s_add_u32 s70, s70, 128
    s_add_u32 s71, s71, 128
    s_add_u32 s72, s72, s74
    s_cmp_ge_u32 s68, 16
    s_cbranch_scc1 k1_nokr
    s_mul_i32 s83, s65, 7552
    s_add_u32 s83, s83, 54272
    v_add_u32 v16, s83, v98
    s_waitcnt vmcnt(12)
    s_xor_b32 s83, s36, 0
    s_mul_i32 s83, s83, 640
    v_add_u32 v17, s83, v16
    ds_read_b64_tr_b16 v[120:121], v17
    ds_read_b64_tr_b16 v[122:123], v17 offset:160
    s_xor_b32 s83, s36, 1
    s_mul_i32 s83, s83, 640
    v_add_u32 v17, s83, v16
    ds_read_b64_tr_b16 v[124:125], v17
    ds_read_b64_tr_b16 v[126:127], v17 offset:160
    s_xor_b32 s83, s36, 2
    s_mul_i32 s83, s83, 640
    v_add_u32 v17, s83, v16
    ds_read_b64_tr_b16 v[128:129], v17
    ds_read_b64_tr_b16 v[130:131], v17 offset:160
    s_xor_b32 s83, s36, 3
    s_mul_i32 s83, s83, 640
    v_add_u32 v17, s83, v16
    ds_read_b64_tr_b16 v[132:133], v17
    ds_read_b64_tr_b16 v[134:135], v17 offset:160
    s_xor_b32 s83, s36, 4
    s_mul_i32 s83, s83, 640
    v_add_u32 v17, s83, v16
    ds_read_b64_tr_b16 v[136:137], v17
    ds_read_b64_tr_b16 v[138:139], v17 offset:160
    s_xor_b32 s83, s36, 5
    s_mul_i32 s83, s83, 640
    v_add_u32 v17, s83, v16
    ds_read_b64_tr_b16 v[140:141], v17
    ds_read_b64_tr_b16 v[142:143], v17 offset:160
    s_waitcnt lgkmcnt(0)
    s_xor_b32 s83, s36, 6
    s_mul_i32 s83, s83, 640
    v_add_u32 v17, s83, v16
    ds_read_b64_tr_b16 v[144:145], v17
    ds_read_b64_tr_b16 v[146:147], v17 offset:160
    s_xor_b32 s83, s36, 7
    s_mul_i32 s83, s83, 640
    v_add_u32 v17, s83, v16
    ds_read_b64_tr_b16 v[148:149], v17
    ds_read_b64_tr_b16 v[150:151], v17 offset:160
    s_xor_b32 s83, s37, 8
    s_mul_i32 s83, s83, 640
    v_add_u32 v17, s83, v16
    ds_read_b64_tr_b16 v[152:153], v17
    ds_read_b64_tr_b16 v[154:155], v17 offset:160
    s_xor_b32 s83, s37, 9
    s_mul_i32 s83, s83, 640
    v_add_u32 v17, s83, v16
    ds_read_b64_tr_b16 v[156:157], v17
    ds_read_b64_tr_b16 v[158:159], v17 offset:160
    s_waitcnt lgkmcnt(0)
k1_nokr:
    s_xor_b32 s82, s37, 2
    s_lshl_b32 s70, s82, 7
    s_add_u32 s71, s70, 40960
    s_mul_i32 s72, s82, s74
    s_add_u32 m0, s75, 103424
    s_nop 0
    buffer_load_dwordx4 v4, s[4:7], s70 offen offset:0 lds
    buffer_load_dwordx4 v5, s[4:7], s70 offen offset:1024 lds
    buffer_load_dwordx4 v6, s[4:7], s70 offen offset:2048 lds
    buffer_load_dwordx4 v7, s[4:7], s70 offen offset:3072 lds
    s_waitcnt lgkmcnt(0)
    s_cmp_ge_u32 s68, 16
    s_cbranch_scc1 x_L1
    s_bitcmp1_b32 s68, 0
    s_cbranch_scc1 x_L2
    v_mfma_f32_32x32x16_bf16 v[80:95], v[120:123], v[72:75], v[80:95]
    s_branch x_L3
x_L2:
    v_mfma_f32_32x32x16_bf16 v[80:95], v[72:75], v[120:123], v[80:95]
x_L3:
x_L1:
    s_add_u32 m0, s75, 107520
    s_nop 0
    buffer_load_dwordx4 v4, s[4:7], s71 offen offset:0 lds
    v_lshlrev_b32 v102, 16, v120
    v_and_b32 v103, v11, v120
    v_add_f32 v102, v102, v103
    v_add_f32 v96, v96, v102
    buffer_load_dwordx4 v5, s[4:7], s71 offen offset:1024 lds
    v_lshlrev_b32 v102, 16, v121
    v_and_b32 v103, v11, v121
    v_add_f32 v102, v102, v103
    v_add_f32 v96, v96, v102
    buffer_load_dwordx4 v6, s[4:7], s71 offen offset:2048 lds
    v_lshlrev_b32 v102, 16, v122
    v_and_b32 v103, v11, v122
    v_add_f32 v102, v102, v103
    v_add_f32 v96, v96, v102
    buffer_load_dwordx4 v7, s[4:7], s71 offen offset:3072 lds
    v_lshlrev_b32 v102, 16, v123
    v_and_b32 v103, v11, v123
    v_add_f32 v102, v102, v103
    v_add_f32 v96, v96, v102
    s_add_u32 m0, s76, 103424
    s_nop 0
    buffer_load_dwordx4 v8, s[8:11], s72 offen offset:0 lds
    buffer_load_dwordx4 v9, s[8:11], s72 offen offset:1024 lds
    s_add_u32 m0, s76, 111616
    s_nop 0
    buffer_load_dwordx4 v8, s[12:15], s72 offen offset:0 lds
    buffer_load_dwordx4 v9, s[12:15], s72 offen offset:1024 lds
    s_add_u32 s70, s70, 128
    s_add_u32 s71, s71, 128
    s_add_u32 s72, s72, s74
    s_waitcnt vmcnt(12)
    s_barrier
    ds_read_b128 v[72:75], v97 offset:51712
    s_xor_b32 s82, s37, 3
    s_lshl_b32 s70, s82, 7
    s_add_u32 s71, s70, 40960
    s_mul_i32 s72, s82, s74
    s_add_u32 m0, s75, 0
    s_nop 0
    buffer_load_dwordx4 v4, s[4:7], s70 offen offset:0 lds
    buffer_load_dwordx4 v5, s[4:7], s70 offen offset:1024 lds
    buffer_load_dwordx4 v6, s[4:7], s70 offen offset:2048 lds
    buffer_load_dwordx4 v7, s[4:7], s70 offen offset:3072 lds
    s_waitcnt lgkmcnt(0)
    s_cmp_ge_u32 s68, 16
    s_cbranch_scc1 x_L4
    s_bitcmp1_b32 s68, 0
    s_cbranch_scc1 x_L5
    v_mfma_f32_32x32x16_bf16 v[80:95], v[124:127], v[72:75], v[80:95]
    s_branch x_L6
x_L5:
    v_mfma_f32_32x32x16_bf16 v[80:95], v[72:75], v[124:127], v[80:95]
x_L6:
x_L4:
    s_add_u32 m0, s75, 4096
    s_nop 0
    buffer_load_dwordx4 v4, s[4:7], s71 offen offset:0 lds
    v_lshlrev_b32 v102, 16, v124
    v_and_b32 v103, v11, v124
    v_add_f32 v102, v102, v103
    v_add_f32 v96, v96, v102
    buffer_load_dwordx4 v5, s[4:7], s71 offen offset:1024 lds
    v_lshlrev_b32 v102, 16, v125
    v_and_b32 v103, v11, v125
    v_add_f32 v102, v102, v103
    v_add_f32 v96, v96, v102
    buffer_load_dwordx4 v6, s[4:7], s71 offen offset:2048 lds
    v_lshlrev_b32 v102, 16, v126
    v_and_b32 v103, v11, v126
    v_add_f32 v102, v102, v103
    v_add_f32 v96, v96, v102
    buffer_load_dwordx4 v7, s[4:7], s71 offen offset:3072 lds
    v_lshlrev_b32 v102, 16, v127
    v_and_b32 v103, v11, v127
    v_add_f32 v102, v102, v103
    v_add_f32 v96, v96, v102
    s_add_u32 m0, s76, 0
    s_nop 0
    buffer_load_dwordx4 v8, s[8:11], s72 offen offset:0 lds
    buffer_load_dwordx4 v9, s[8:11], s72 offen offset:1024 lds
    s_add_u32 m0, s76, 8192
    s_nop 0
    buffer_load_dwordx4 v8, s[12:15], s72 offen offset:0 lds
    buffer_load_dwordx4 v9, s[12:15], s72 offen offset:1024 lds
    s_add_u32 s70, s70, 128
    s_add_u32 s71, s71, 128
    s_add_u32 s72, s72, s74
    s_waitcnt vmcnt(12)
    s_barrier
    ds_read_b128 v[72:75], v99 offset:0
    s_xor_b32 s82, s37, 4
    s_lshl_b32 s70, s82, 7
    s_add_u32 s71, s70, 40960
    s_mul_i32 s72, s82, s74
    s_add_u32 m0, s75, 51712
    s_nop 0
    buffer_load_dwordx4 v4, s[4:7], s70 offen offset:0 lds
    buffer_load_dwordx4 v5, s[4:7], s70 offen offset:1024 lds
    buffer_load_dwordx4 v6, s[4:7], s70 offen offset:2048 lds
    buffer_load_dwordx4 v7, s[4:7], s70 offen offset:3072 lds
    s_waitcnt lgkmcnt(0)
    s_cmp_ge_u32 s68, 16
    s_cbranch_scc1 x_L7
    s_bitcmp1_b32 s68, 0
    s_cbranch_scc1 x_L8
    v_mfma_f32_32x32x16_bf16 v[80:95], v[128:131], v[72:75], v[80:95]
    s_branch x_L9
x_L8:
    v_mfma_f32_32x32x16_bf16 v[80:95], v[72:75], v[128:131], v[80:95]
x_L9:
x_L7:
    s_add_u32 m0, s75, 55808
    s_nop 0
    buffer_load_dwordx4 v4, s[4:7], s71 offen offset:0 lds
    v_lshlrev_b32 v102, 16, v128
    v_and_b32 v103, v11, v128
    v_add_f32 v102, v102, v103
    v_add_f32 v96, v96, v102
    buffer_load_dwordx4 v5, s[4:7], s71 offen offset:1024 lds
    v_lshlrev_b32 v102, 16, v129
    v_and_b32 v103, v11, v129
    v_add_f32 v102, v102, v103
    v_add_f32 v96, v96, v102
    buffer_load_dwordx4 v6, s[4:7], s71 offen offset:2048 lds
    v_lshlrev_b32 v102, 16, v130
    v_and_b32 v103, v11, v130
    v_add_f32 v102, v102, v103
    v_add_f32 v96, v96, v102
    buffer_load_dwordx4 v7, s[4:7], s71 offen offset:3072 lds
    v_lshlrev_b32 v102, 16, v131
    v_and_b32 v103, v11, v131
    v_add_f32 v102, v102, v103
    v_add_f32 v96, v96, v102
    s_add_u32 m0, s76, 51712
    s_nop 0
    buffer_load_dwordx4 v8, s[8:11], s72 offen offset:0 lds
    buffer_load_dwordx4 v9, s[8:11], s72 offen offset:1024 lds
    s_add_u32 m0, s76, 59904
    s_nop 0
    buffer_load_dwordx4 v8, s[12:15], s72 offen offset:0 lds
    buffer_load_dwordx4 v9, s[12:15], s72 offen offset:1024 lds
    s_add_u32 s70, s70, 128
    s_add_u32 s71, s71, 128
    s_add_u32 s72, s72, s74
    s_waitcnt vmcnt(12)
    s_barrier
    ds_read_b128 v[72:75], v97 offset:0
    s_xor_b32 s82, s37, 5
    s_lshl_b32 s70, s82, 7
    s_add_u32 s71, s70, 40960
    s_mul_i32 s72, s82, s74
    s_add_u32 m0, s75, 103424
    s_nop 0
    buffer_load_dwordx4 v4, s[4:7], s70 offen offset:0 lds
    buffer_load_dwordx4 v5, s[4:7], s70 offen offset:1024 lds
    buffer_load_dwordx4 v6, s[4:7], s70 offen offset:2048 lds
    buffer_load_dwordx4 v7, s[4:7], s70 offen offset:3072 lds
    s_waitcnt lgkmcnt(0)
    s_cmp_ge_u32 s68, 16
    s_cbranch_scc1 x_L10
    s_bitcmp1_b32 s68, 0
    s_cbranch_scc1 x_L11
    v_mfma_f32_32x32x16_bf16 v[80:95], v[132:135], v[72:75], v[80:95]
    s_branch x_L12
x_L11:
    v_mfma_f32_32x32x16_bf16 v[80:95], v[72:75], v[132:135], v[80:95]
x_L12:
x_L10:
    s_add_u32 m0, s75, 107520
    s_nop 0
    buffer_load_dwordx4 v4, s[4:7], s71 offen offset:0 lds
    v_lshlrev_b32 v102, 16, v132
    v_and_b32 v103, v11, v132
    v_add_f32 v102, v102, v103
    v_add_f32 v96, v96, v102
    buffer_load_dwordx4 v5, s[4:7], s71 offen offset:1024 lds
    v_lshlrev_b32 v102, 16, v133
    v_and_b32 v103, v11, v133
    v_add_f32 v102, v102, v103
    v_add_f32 v96, v96, v102
    buffer_load_dwordx4 v6, s[4:7], s71 offen offset:2048 lds
    v_lshlrev_b32 v102, 16, v134
    v_and_b32 v103, v11, v134
    v_add_f32 v102, v102, v103
    v_add_f32 v96, v96, v102
    buffer_load_dwordx4 v7, s[4:7], s71 offen offset:3072 lds
    v_lshlrev_b32 v102, 16, v135
    v_and_b32 v103, v11, v135
    v_add_f32 v102, v102, v103
    v_add_f32 v96, v96, v102
    s_add_u32 m0, s76, 103424
    s_nop 0
    buffer_load_dwordx4 v8, s[8:11], s72 offen offset:0 lds
    buffer_load_dwordx4 v9, s[8:11], s72 offen offset:1024 lds
    s_add_u32 m0, s76, 111616
    s_nop 0
    buffer_load_dwordx4 v8, s[12:15], s72 offen offset:0 lds
    buffer_load_dwordx4 v9, s[12:15], s72 offen offset:1024 lds
    s_add_u32 s70, s70, 128
    s_add_u32 s71, s71, 128
    s_add_u32 s72, s72, s74
    s_waitcnt vmcnt(12)
    s_barrier
    ds_read_b128 v[72:75], v97 offset:51712
    s_xor_b32 s82, s37, 6
    s_lshl_b32 s70, s82, 7
    s_add_u32 s71, s70, 40960
    s_mul_i32 s72, s82, s74
    s_add_u32 m0, s75, 0
    s_nop 0
    buffer_load_dwordx4 v4, s[4:7], s70 offen offset:0 lds
    buffer_load_dwordx4 v5, s[4:7], s70 offen offset:1024 lds
    buffer_load_dwordx4 v6, s[4:7], s70 offen offset:2048 lds
    buffer_load_dwordx4 v7, s[4:7], s70 offen offset:3072 lds
    s_waitcnt lgkmcnt(0)
    s_cmp_ge_u32 s68, 16
    s_cbranch_scc1 x_L13
    s_bitcmp1_b32 s68, 0
    s_cbranch_scc1 x_L14
    v_mfma_f32_32x32x16_bf16 v[80:95], v[136:139], v[72:75], v[80:95]
    s_branch x_L15
x_L14:
    v_mfma_f32_32x32x16_bf16 v[80:95], v[72:75], v[136:139], v[80:95]
x_L15:
x_L13:
    s_add_u32 m0, s75, 4096
    s_nop 0
    buffer_load_dwordx4 v4, s[4:7], s71 offen offset:0 lds
    v_lshlrev_b32 v102, 16, v136
    v_and_b32 v103, v11, v136
    v_add_f32 v102, v102, v103
    v_add_f32 v96, v96, v102
    buffer_load_dwordx4 v5, s[4:7], s71 offen offset:1024 lds
    v_lshlrev_b32 v102, 16, v137
    v_and_b32 v103, v11, v137
    v_add_f32 v102, v102, v103
    v_add_f32 v96, v96, v102
    buffer_load_dwordx4 v6, s[4:7], s71 offen offset:2048 lds
    v_lshlrev_b32 v102, 16, v138
    v_and_b32 v103, v11, v138
    v_add_f32 v102, v102, v103
    v_add_f32 v96, v96, v102
    buffer_load_dwordx4 v7, s[4:7], s71 offen offset:3072 lds
    v_lshlrev_b32 v102, 16, v139
    v_and_b32 v103, v11, v139
    v_add_f32 v102, v102, v103
    v_add_f32 v96, v96, v102
    s_add_u32 m0, s76, 0
    s_nop 0
    buffer_load_dwordx4 v8, s[8:11], s72 offen offset:0 lds
    buffer_load_dwordx4 v9, s[8:11], s72 offen offset:1024 lds
    s_add_u32 m0, s76, 8192
    s_nop 0
    buffer_load_dwordx4 v8, s[12:15], s72 offen offset:0 lds
    buffer_load_dwordx4 v9, s[12:15], s72 offen offset:1024 lds
    s_add_u32 s70, s70, 128
    s_add_u32 s71, s71, 128
    s_add_u32 s72, s72, s74
    s_waitcnt vmcnt(12)
    s_barrier
    ds_read_b128 v[72:75], v99 offset:0
    s_xor_b32 s82, s37, 7
    s_lshl_b32 s70, s82, 7
    s_add_u32 s71, s70, 40960
    s_mul_i32 s72, s82, s74
    s_add_u32 m0, s75, 51712
    s_nop 0
    buffer_load_dwordx4 v4, s[4:7], s70 offen offset:0 lds
    buffer_load_dwordx4 v5, s[4:7], s70 offen offset:1024 lds
    buffer_load_dwordx4 v6, s[4:7], s70 offen offset:2048 lds
    buffer_load_dwordx4 v7, s[4:7], s70 offen offset:3072 lds
    s_waitcnt lgkmcnt(0)
    s_cmp_ge_u32 s68, 16
    s_cbranch_scc1 x_L16
    s_bitcmp1_b32 s68, 0
    s_cbranch_scc1 x_L17
    v_mfma_f32_32x32x16_bf16 v[80:95], v[140:143], v[72:75], v[80:95]
    s_branch x_L18
x_L17:
    v_mfma_f32_32x32x16_bf16 v[80:95], v[72:75], v[140:143], v[80:95]
x_L18:
x_L16:
    s_add_u32 m0, s75, 55808
    s_nop 0
    buffer_load_dwordx4 v4, s[4:7], s71 offen offset:0 lds
    v_lshlrev_b32 v102, 16, v140
    v_and_b32 v103, v11, v140
    v_add_f32 v102, v102, v103
    v_add_f32 v96, v96, v102
    buffer_load_dwordx4 v5, s[4:7], s71 offen offset:1024 lds
    v_lshlrev_b32 v102, 16, v141
    v_and_b32 v103, v11, v141
    v_add_f32 v102, v102, v103
    v_add_f32 v96, v96, v102
    buffer_load_dwordx4 v6, s[4:7], s71 offen offset:2048 lds
    v_lshlrev_b32 v102, 16, v142
    v_and_b32 v103, v11, v142
    v_add_f32 v102, v102, v103
    v_add_f32 v96, v96, v102
    buffer_load_dwordx4 v7, s[4:7], s71 offen offset:3072 lds
    v_lshlrev_b32 v102, 16, v143
    v_and_b32 v103, v11, v143
    v_add_f32 v102, v102, v103
    v_add_f32 v96, v96, v102
    s_add_u32 m0, s76, 51712
    s_nop 0
    buffer_load_dwordx4 v8, s[8:11], s72 offen offset:0 lds
    buffer_load_dwordx4 v9, s[8:11], s72 offen offset:1024 lds
    s_add_u32 m0, s76, 59904
    s_nop 0
    buffer_load_dwordx4 v8, s[12:15], s72 offen offset:0 lds
    buffer_load_dwordx4 v9, s[12:15], s72 offen offset:1024 lds
    s_add_u32 s70, s70, 128
    s_add_u32 s71, s71, 128
    s_add_u32 s72, s72, s74
    s_waitcnt vmcnt(12)
    s_barrier
    ds_read_b128 v[72:75], v97 offset:0
    s_xor_b32 s82, s37, 8
    s_lshl_b32 s70, s82, 7
    s_add_u32 s71, s70, 40960
    s_mul_i32 s72, s82, s74
    s_add_u32 m0, s75, 103424
    s_nop 0
    buffer_load_dwordx4 v4, s[4:7], s70 offen offset:0 lds
    buffer_load_dwordx4 v5, s[4:7], s70 offen offset:1024 lds
    buffer_load_dwordx4 v6, s[4:7], s70 offen offset:2048 lds
    buffer_load_dwordx4 v7, s[4:7], s70 offen offset:3072 lds
    s_waitcnt lgkmcnt(0)
    s_cmp_ge_u32 s68, 16
    s_cbranch_scc1 x_L19
    s_bitcmp1_b32 s68, 0
    s_cbranch_scc1 x_L20
    v_mfma_f32_32x32x16_bf16 v[80:95], v[144:147], v[72:75], v[80:95]
    s_branch x_L21
x_L20:
    v_mfma_f32_32x32x16_bf16 v[80:95], v[72:75], v[144:147], v[80:95]
x_L21:
x_L19:
    s_add_u32 m0, s75, 107520
    s_nop 0
    buffer_load_dwordx4 v4, s[4:7], s71 offen offset:0 lds
    v_lshlrev_b32 v102, 16, v144
    v_and_b32 v103, v11, v144
    v_add_f32 v102, v102, v103
    v_add_f32 v96, v96, v102
    buffer_load_dwordx4 v5, s[4:7], s71 offen offset:1024 lds
    v_lshlrev_b32 v102, 16, v145
    v_and_b32 v103, v11, v145
    v_add_f32 v102, v102, v103
    v_add_f32 v96, v96, v102
    buffer_load_dwordx4 v6, s[4:7], s71 offen offset:2048 lds
    v_lshlrev_b32 v102, 16, v146
    v_and_b32 v103, v11, v146
    v_add_f32 v102, v102, v103
    v_add_f32 v96, v96, v102
    buffer_load_dwordx4 v7, s[4:7], s71 offen offset:3072 lds
    v_lshlrev_b32 v102, 16, v147
    v_and_b32 v103, v11, v147
    v_add_f32 v102, v102, v103
    v_add_f32 v96, v96, v102
    s_add_u32 m0, s76, 103424
    s_nop 0
    buffer_load_dwordx4 v8, s[8:11], s72 offen offset:0 lds
    buffer_load_dwordx4 v9, s[8:11], s72 offen offset:1024 lds
    s_add_u32 m0, s76, 111616
    s_nop 0
    buffer_load_dwordx4 v8, s[12:15], s72 offen offset:0 lds
    buffer_load_dwordx4 v9, s[12:15], s72 offen offset:1024 lds
    s_add_u32 s70, s70, 128
    s_add_u32 s71, s71, 128
    s_add_u32 s72, s72, s74
    v_and_b32 v18, 0, v1
    v_lshlrev_b32 v18, 2, v18
    s_lshl_b32 s79, s67, 5
    buffer_load_dword v19, v18, s[24:27], s79 offen sc1
    s_waitcnt vmcnt(13)
    s_barrier
    ds_read_b128 v[72:75], v97 offset:51712
    s_xor_b32 s82, s37, 9
    s_lshl_b32 s70, s82, 7
    s_add_u32 s71, s70, 40960
    s_mul_i32 s72, s82, s74
    s_add_u32 m0, s75, 0
    s_nop 0
    buffer_load_dwordx4 v4, s[4:7], s70 offen offset:0 lds
    buffer_load_dwordx4 v5, s[4:7], s70 offen offset:1024 lds
    buffer_load_dwordx4 v6, s[4:7], s70 offen offset:2048 lds
    buffer_load_dwordx4 v7, s[4:7], s70 offen offset:3072 lds
    s_waitcnt lgkmcnt(0)
    s_cmp_ge_u32 s68, 16
    s_cbranch_scc1 x_L22
    s_bitcmp1_b32 s68, 0
    s_cbranch_scc1 x_L23
    v_mfma_f32_32x32x16_bf16 v[80:95], v[148:151], v[72:75], v[80:95]
    s_branch x_L24
x_L23:
    v_mfma_f32_32x32x16_bf16 v[80:95], v[72:75], v[148:151], v[80:95]
x_L24:
x_L22:
    s_add_u32 m0, s75, 4096
    s_nop 0
    buffer_load_dwordx4 v4, s[4:7], s71 offen offset:0 lds
    v_lshlrev_b32 v102, 16, v148
    v_and_b32 v103, v11, v148
    v_add_f32 v102, v102, v103
    v_add_f32 v96, v96, v102
    buffer_load_dwordx4 v5, s[4:7], s71 offen offset:1024 lds
    v_lshlrev_b32 v102, 16, v149
    v_and_b32 v103, v11, v149
    v_add_f32 v102, v102, v103
    v_add_f32 v96, v96, v102
    buffer_load_dwordx4 v6, s[4:7], s71 offen offset:2048 lds
    v_lshlrev_b32 v102, 16, v150
    v_and_b32 v103, v11, v150
    v_add_f32 v102, v102, v103
    v_add_f32 v96, v96, v102
    buffer_load_dwordx4 v7, s[4:7], s71 offen offset:3072 lds
    v_lshlrev_b32 v102, 16, v151
    v_and_b32 v103, v11, v151
    v_add_f32 v102, v102, v103
    v_add_f32 v96, v96, v102
    s_add_u32 m0, s76, 0
    s_nop 0
    buffer_load_dwordx4 v8, s[8:11], s72 offen offset:0 lds
    buffer_load_dwordx4 v9, s[8:11], s72 offen offset:1024 lds
    s_add_u32 m0, s76, 8192
    s_nop 0
    buffer_load_dwordx4 v8, s[12:15], s72 offen offset:0 lds
    buffer_load_dwordx4 v9, s[12:15], s72 offen offset:1024 lds
    s_add_u32 s70, s70, 128
    s_add_u32 s71, s71, 128
    s_add_u32 s72, s72, s74
    s_waitcnt vmcnt(12)
    s_mov_b32 s82, 262144
x_L25:
    v_cmp_ne_u32 vcc, -1, v19
    s_nop 1
    s_cbranch_vccz x_L26
    s_sub_u32 s82, s82, 1
    s_cbranch_scc1 x_L26
    s_sleep 4
    buffer_load_dword v19, v18, s[24:27], s79 offen sc1
    s_waitcnt vmcnt(0)
    s_branch x_L25
x_L26:
    s_lshl_b32 s82, s67, 12
    s_lshl_b32 s83, s65, 10
    s_add_u32 s82, s82, s83
    s_add_u32 s82, s82, 14680064
    s_lshl_b32 s83, s65, 8
    s_add_u32 s83, s83, 160256
    v_add_u32 v18, s83, v12
    v_lshrrev_b32 v20, 3, v1
    v_lshlrev_b32 v20, 7, v20
    v_and_b32 v21, 7, v1
    v_lshl_add_u32 v19, v21, 3, v20
    buffer_load_dwordx2 v[20:21], v19, s[20:23], s82 offen sc1
    v_and_b32 v13, 224, v12
    buffer_load_dword v15, v13, s[24:27], 0 offen sc1
    s_barrier
    ds_read_b128 v[72:75], v99 offset:0
    s_waitcnt lgkmcnt(0)
    s_cmp_ge_u32 s68, 16
    s_cbranch_scc1 x_L27
    s_bitcmp1_b32 s68, 0
    s_cbranch_scc1 x_L28
    v_mfma_f32_32x32x16_bf16 v[80:95], v[152:155], v[72:75], v[80:95]
    s_branch x_L29
x_L28:
    v_mfma_f32_32x32x16_bf16 v[80:95], v[72:75], v[152:155], v[80:95]
x_L29:
x_L27:
    v_lshlrev_b32 v102, 16, v152
    v_and_b32 v103, v11, v152
    v_add_f32 v102, v102, v103
    v_add_f32 v96, v96, v102
    v_lshlrev_b32 v102, 16, v153
    v_and_b32 v103, v11, v153
    v_add_f32 v102, v102, v103
    v_add_f32 v96, v96, v102
    v_lshlrev_b32 v102, 16, v154
    v_and_b32 v103, v11, v154
    v_add_f32 v102, v102, v103
    v_add_f32 v96, v96, v102
    v_lshlrev_b32 v102, 16, v155
    v_and_b32 v103, v11, v155
    v_add_f32 v102, v102, v103
    v_add_f32 v96, v96, v102
    s_lshl_b32 s82, s2, 2
    s_add_u32 s82, s82, s65
    s_add_u32 s82, s82, 0
    s_mul_i32 s83, s82, 52429
    s_lshr_b32 s83, s83, 19
    s_mul_i32 s84, s83, 10
    s_sub_u32 s84, s82, s84
    s_mul_i32 s80, s84, 296
    s_add_u32 s80, s80, s83
    s_lshl_b32 s80, s80, 10
    s_add_u32 s80, s80, 11534336
    s_lshl_b32 s85, s83, 4
    s_mov_b32 s86, 10240
    s_mov_b32 s87, 5120
    s_mov_b32 s32, s56
    s_mov_b32 s33, s57
    s_mov_b32 s34, 2211840
    s_mov_b32 s35, 0x20000
    s_mul_i32 s85, s85, 1280
    s_lshl_b32 s84, s84, 7
    s_add_u32 s85, s85, s84
    s_add_u32 s87, s87, s85
    v_bfe_u32 v40, v1, 3, 2
    v_mul_u32_u24 v40, 1280, v40
    v_lshrrev_b32 v41, 5, v1
    v_mad_u32_u24 v40, v41, s86, v40
    v_bfe_u32 v41, v1, 4, 1
    v_lshlrev_b32 v41, 2, v41
    v_and_b32 v42, 7, v1
    v_xor_b32 v41, v41, v42
    v_lshl_add_u32 v40, v41, 4, v40
    s_lshl_b32 s88, s65, 12
    s_add_u32 m0, s88, 64000
    s_nop 0
    buffer_load_dwordx4 v40, s[32:35], s85 offen lds
    s_add_u32 m0, m0, 1024
    s_nop 0
    buffer_load_dwordx4 v40, s[32:35], s87 offen lds
    s_lshl_b32 s82, s2, 2
    s_add_u32 s82, s82, s65
    s_add_u32 s82, s82, 1024
    s_mul_i32 s83, s82, 52429
    s_lshr_b32 s83, s83, 19
    s_mul_i32 s84, s83, 10
    s_sub_u32 s84, s82, s84
    s_mul_i32 s81, s84, 296
    s_add_u32 s81, s81, s83
    s_lshl_b32 s81, s81, 10
    s_add_u32 s81, s81, 11534336
    s_lshl_b32 s85, s83, 4
    s_sub_u32 s88, s83, 108
    s_mul_i32 s88, s88, 20
    s_sub_u32 s89, s83, 140
    s_mul_i32 s89, s89, 80
    s_add_u32 s89, s89, 16
    s_cmp_lt_u32 s83, 108
    s_cselect_b32 s85, s85, s88
    s_cselect_b32 s32, s56, s48
    s_cselect_b32 s33, s57, s49
    s_mov_b32 s34, 819200
    s_cselect_b32 s34, 2211840, s34
    s_mov_b32 s35, 0x20000
    s_cmp_lt_u32 s83, 140
    s_cselect_b32 s85, s85, s89
    s_mov_b32 s86, 25600
    s_mov_b32 s87, 51200
    s_cselect_b32 s86, 10240, s86
    s_cselect_b32 s87, 5120, s87
    s_cmp_lt_u32 s83, 148
    s_cselect_b32 s34, s34, 0
    s_cselect_b32 s81, s81, 33554432
    s_mul_i32 s85, s85, 1280
    s_lshl_b32 s84, s84, 7
    s_add_u32 s85, s85, s84
    s_add_u32 s87, s87, s85
    v_bfe_u32 v40, v1, 3, 2
    v_mul_u32_u24 v40, 1280, v40
    v_lshrrev_b32 v41, 5, v1
    v_mad_u32_u24 v40, v41, s86, v40
    v_bfe_u32 v41, v1, 4, 1
    v_lshlrev_b32 v41, 2, v41
    v_and_b32 v42, 7, v1
    v_xor_b32 v41, v41, v42
    v_lshl_add_u32 v40, v41, 4, v40
    s_lshl_b32 s88, s65, 12
    s_add_u32 m0, s88, 66048
    s_nop 0
    buffer_load_dwordx4 v40, s[32:35], s85 offen lds
    s_add_u32 m0, m0, 1024
    s_nop 0
    buffer_load_dwordx4 v40, s[32:35], s87 offen lds
    s_waitcnt vmcnt(5)
    ds_write_b32 v18, v21
    ds_write_b32 v18, v20 offset:1024
    v_mov_b32 v22, 80384
    v_mov_b32 v24, 0
    v_mov_b32 v25, 0
    ds_write_b64 v22, v[24:25]
    ds_write_b64 v22, v[24:25] offset:8
    s_waitcnt lgkmcnt(0)
    s_waitcnt vmcnt(4)
    v_cmp_ne_u32 vcc, -1, v15
    s_nop 1
    s_cbranch_vccz x_L30
    s_mov_b32 s82, 0x40000
x_L31:
    buffer_load_dword v15, v13, s[24:27], 0 offen sc1
    s_waitcnt vmcnt(0)
    v_cmp_ne_u32 vcc, -1, v15
    s_sub_u32 s82, s82, 1
    s_cbranch_vccz x_L31x
    s_sleep 4
    s_cbranch_scc0 x_L31
x_L31x:
x_L30:
    s_barrier
    ds_read_b128 v[72:75], v97 offset:0
    s_waitcnt lgkmcnt(0)
    s_cmp_ge_u32 s68, 16
    s_cbranch_scc1 x_L32
    s_bitcmp1_b32 s68, 0
    s_cbranch_scc1 x_L33
    v_mfma_f32_32x32x16_bf16 v[80:95], v[156:159], v[72:75], v[80:95]
    s_branch x_L34
x_L33:
    v_mfma_f32_32x32x16_bf16 v[80:95], v[72:75], v[156:159], v[80:95]
x_L34:
x_L32:
    v_lshlrev_b32 v102, 16, v156
    v_and_b32 v103, v11, v156
    v_add_f32 v102, v102, v103
    v_add_f32 v96, v96, v102
    v_lshlrev_b32 v102, 16, v157
    v_and_b32 v103, v11, v157
    v_add_f32 v102, v102, v103
    v_add_f32 v96, v96, v102
    v_lshlrev_b32 v102, 16, v158
    v_and_b32 v103, v11, v158
    v_add_f32 v102, v102, v103
    v_add_f32 v96, v96, v102
    v_lshlrev_b32 v102, 16, v159
    v_and_b32 v103, v11, v159
    v_add_f32 v102, v102, v103
    v_add_f32 v96, v96, v102
    s_cmp_ge_u32 s68, 16
    s_cbranch_scc1 k1_kv0
    s_lshr_b32 s89, s68, 1
    s_lshl_b32 s82, s89, 7
    s_add_u32 s82, s82, 160256
    v_and_b32 v16, 31, v1
    v_lshlrev_b32 v16, 2, v16
    v_add_u32 v16, s82, v16
    v_lshrrev_b32 v19, 5, v1
    v_lshlrev_b32 v19, 4, v19
    v_add_u32 v19, s82, v19
    ds_read_b32 v17, v16
    ds_read_b32 v18, v16 offset:1024
    ds_read_b128 v[40:43], v19 offset:1024
    ds_read_b128 v[44:47], v19 offset:1056
    ds_read_b128 v[48:51], v19 offset:1088
    ds_read_b128 v[52:55], v19 offset:1120
    s_mov_b32 s83, 0x07060302
    v_and_b32 v20, v11, v96
    v_sub_f32 v21, v96, v20
    v_and_b32 v22, v11, v21
    v_perm_b32 v76, v22, v20, s83
    v_sub_f32 v21, v21, v22
    v_lshrrev_b32 v77, 16, v21
    v_mov_b32 v78, 0
    v_mov_b32 v79, 0
    v_mov_b32 v74, 0
    v_mov_b32 v75, 0
    s_waitcnt lgkmcnt(0)
    v_xor_b32 v17, 0x80000000, v17
    v_perm_b32 v72, v17, v17, s83
    v_mov_b32 v73, v72
    s_bitcmp1_b32 s68, 0
    s_cbranch_scc1 x_L35
    v_mfma_f32_32x32x16_bf16 v[80:95], v[76:79], v[72:75], v[80:95]
    s_branch x_L36
x_L35:
    v_mfma_f32_32x32x16_bf16 v[80:95], v[72:75], v[76:79], v[80:95]
x_L36:
    s_lshl_b32 s82, s65, 12
    s_add_u32 s82, s82, 47616
    v_add_u32 v20, s82, v2
    s_lshl_b32 s82, s65, 2
    s_add_u32 s82, s82, 80384
    v_mov_b32 v22, s82
    v_mov_b32 v23, 1
    s_cmp_eq_u32 s65, 0
    s_cbranch_scc1 k1_kvfin
    s_nop 3
    ds_write_b128 v20, v[80:83] offset:0
    ds_write_b128 v20, v[84:87] offset:1024
    ds_write_b128 v20, v[88:91] offset:2048
    ds_write_b128 v20, v[92:95] offset:3072
    s_waitcnt lgkmcnt(0)
    ds_write_b32 v22, v23
    s_branch k1_kv0
k1_kvfin:
    s_lshl_b32 s87, s67, 3
    s_add_u32 s87, s87, s89
    s_mul_i32 s86, s87, 2560
    s_add_u32 s86, s86, 10485760
    s_lshr_b32 s78, s87, 2
    s_lshl_b32 s78, s78, 7
    s_and_b32 s88, s87, 3
    s_lshl_b32 s88, s88, 2
    s_add_u32 s78, s78, s88
k1_kvw:
    ds_read_b128 v[24:27], v22
    s_waitcnt lgkmcnt(0)
    v_and_b32 v25, v25, v26
    v_and_b32 v25, v25, v27
    v_cmp_ne_u32 vcc, 1, v25
    s_nop 1
    s_cbranch_vccnz k1_kvw
    ds_read_b128 v[104:107], v20 offset:4096
    ds_read_b128 v[108:111], v20 offset:5120
    ds_read_b128 v[112:115], v20 offset:6144
    ds_read_b128 v[116:119], v20 offset:7168
    ds_read_b128 v[120:123], v20 offset:8192
    ds_read_b128 v[124:127], v20 offset:9216
    ds_read_b128 v[128:131], v20 offset:10240
    ds_read_b128 v[132:135], v20 offset:11264
    ds_read_b128 v[136:139], v20 offset:12288
    ds_read_b128 v[140:143], v20 offset:13312
    ds_read_b128 v[144:147], v20 offset:14336
    ds_read_b128 v[148:151], v20 offset:15360
    s_waitcnt lgkmcnt(8)
    v_add_f32 v80, v80, v104
    v_add_f32 v81, v81, v105
    v_add_f32 v82, v82, v106
    v_add_f32 v83, v83, v107
    v_add_f32 v84, v84, v108
    v_add_f32 v85, v85, v109
    v_add_f32 v86, v86, v110
    v_add_f32 v87, v87, v111
    v_add_f32 v88, v88, v112
    v_add_f32 v89, v89, v113
    v_add_f32 v90, v90, v114
    v_add_f32 v91, v91, v115
    v_add_f32 v92, v92, v116
    v_add_f32 v93, v93, v117
    v_add_f32 v94, v94, v118
    v_add_f32 v95, v95, v119
    s_waitcnt lgkmcnt(4)
    v_add_f32 v80, v80, v120
    v_add_f32 v81, v81, v121
    v_add_f32 v82, v82, v122
    v_add_f32 v83, v83, v123
    v_add_f32 v84, v84, v124
    v_add_f32 v85, v85, v125
    v_add_f32 v86, v86, v126
    v_add_f32 v87, v87, v127
    v_add_f32 v88, v88, v128
    v_add_f32 v89, v89, v129
    v_add_f32 v90, v90, v130
    v_add_f32 v91, v91, v131
    v_add_f32 v92, v92, v132
    v_add_f32 v93, v93, v133
    v_add_f32 v94, v94, v134
    v_add_f32 v95, v95, v135
    s_waitcnt lgkmcnt(0)
    v_add_f32 v80, v80, v136
    v_add_f32 v81, v81, v137
    v_add_f32 v82, v82, v138
    v_add_f32 v83, v83, v139
    v_add_f32 v84, v84, v140
    v_add_f32 v85, v85, v141
    v_add_f32 v86, v86, v142
    v_add_f32 v87, v87, v143
    v_add_f32 v88, v88, v144
    v_add_f32 v89, v89, v145
    v_add_f32 v90, v90, v146
    v_add_f32 v91, v91, v147
    v_add_f32 v92, v92, v148
    v_add_f32 v93, v93, v149
    v_add_f32 v94, v94, v150
    v_add_f32 v95, v95, v151
    s_bitcmp1_b32 s68, 0
    s_cbranch_scc1 k1_epiv
    v_mul_f32 v80, v80, v18
    v_mul_f32 v81, v81, v18
    v_mul_f32 v82, v82, v18
    v_mul_f32 v83, v83, v18
    v_mul_f32 v84, v84, v18
    v_mul_f32 v85, v85, v18
    v_mul_f32 v86, v86, v18
    v_mul_f32 v87, v87, v18
    v_mul_f32 v88, v88, v18
    v_mul_f32 v89, v89, v18
    v_mul_f32 v90, v90, v18
    v_mul_f32 v91, v91, v18
    v_cvt_pk_bf16_f32 v104, v80, v81
    v_cvt_pk_bf16_f32 v105, v82, v83
    v_cvt_pk_bf16_f32 v106, v84, v85
    v_cvt_pk_bf16_f32 v107, v86, v87
    v_cvt_pk_bf16_f32 v108, v88, v89
    v_cvt_pk_bf16_f32 v109, v90, v91
    v_mul_f32 v16, v80, v80
    buffer_store_dwordx4 v[104:107], v2, s[20:23], s86 offen sc0 sc1
    v_permlane32_swap_b32 v108, v109
    buffer_store_dword v108, v12, s[20:23], s86 offen offset:1024 sc0 sc1
    v_fmac_f32 v16, v81, v81
    v_fmac_f32 v16, v82, v82
    v_fmac_f32 v16, v83, v83
    v_fmac_f32 v16, v84, v84
    v_fmac_f32 v16, v85, v85
    v_fmac_f32 v16, v86, v86
    v_fmac_f32 v16, v87, v87
    s_mov_b32 exec_hi, 0
    v_fmac_f32 v16, v88, v88
    v_fmac_f32 v16, v89, v89
    v_fmac_f32 v16, v90, v90
    v_fmac_f32 v16, v91, v91
    s_mov_b64 exec, -1
    v_mov_b32 v17, v16
    s_add_u32 s78, s78, 14852096
    s_nop 0
    v_permlane32_swap_b32 v16, v17
    v_add_f32 v16, v16, v17
    s_nop 1
    v_max_f32_dpp v16, v16, v16 row_shr:1 row_mask:0xf bank_mask:0xf
    s_nop 1
    v_max_f32_dpp v16, v16, v16 row_shr:2 row_mask:0xf bank_mask:0xf
    s_nop 1
    v_max_f32_dpp v16, v16, v16 row_shr:4 row_mask:0xf bank_mask:0xf
    s_nop 1
    v_max_f32_dpp v16, v16, v16 row_shr:8 row_mask:0xf bank_mask:0xf
    s_nop 1
    v_max_f32_dpp v16, v16, v16 row_bcast:15 row_mask:0xa bank_mask:0xf
    s_nop 0
    v_readlane_b32 s88, v16, 31
    s_nop 0
    s_or_b32 s88, s88, 1
    v_mov_b32 v23, s88
    s_branch k1_kvfl
k1_epiv:
    v_mul_f32 v80, v80, v40
    v_mul_f32 v81, v81, v41
    v_mul_f32 v82, v82, v42
    v_mul_f32 v83, v83, v43
    v_mul_f32 v84, v84, v44
    v_mul_f32 v85, v85, v45
    v_mul_f32 v86, v86, v46
    v_mul_f32 v87, v87, v47
    v_mul_f32 v88, v88, v48
    v_mul_f32 v89, v89, v49
    v_mul_f32 v90, v90, v50
    v_mul_f32 v91, v91, v51
    v_mul_f32 v92, v92, v52
    v_mul_f32 v93, v93, v53
    v_mul_f32 v94, v94, v54
    v_mul_f32 v95, v95, v55
    v_cvt_pk_bf16_f32 v80, v80, v81
    v_cvt_pk_bf16_f32 v81, v82, v83
    v_cvt_pk_bf16_f32 v82, v84, v85
    v_cvt_pk_bf16_f32 v83, v86, v87
    v_cvt_pk_bf16_f32 v84, v88, v89
    v_cvt_pk_bf16_f32 v85, v90, v91
    v_cvt_pk_bf16_f32 v86, v92, v93
    v_cvt_pk_bf16_f32 v87, v94, v95
    v_and_b32 v16, 31, v1
    v_lshrrev_b32 v17, 5, v1
    v_lshlrev_b32 v16, 4, v16
    v_mul_u32_u24 v17, 320, v17
    v_add_u32 v16, v16, v17
    s_add_u32 s78, s78, 14854144
    s_mov_b32 exec_lo, 0xfffff
    s_mov_b32 exec_hi, 0xfffff
    buffer_store_dwordx4 v[80:83], v16, s[20:23], s86 offen offset:1280 sc0 sc1
    buffer_store_dwordx4 v[84:87], v16, s[20:23], s86 offen offset:1920 sc0 sc1
    s_mov_b64 exec, -1
k1_kvfl:
    s_nop 0
    v_lshlrev_b32 v22, 12, v1
    s_waitcnt vmcnt(0)
    s_mov_b64 exec, 0xff
    buffer_store_dword v23, v22, s[20:23], s78 offen sc1
    s_mov_b64 exec, -1
    s_branch k1_pack
k1_kv0:
k1_pack:
    v_lshrrev_b32 v40, 5, v1
    v_bfe_u32 v41, v1, 2, 2
    v_lshl_add_u32 v40, v40, 3, v41
    v_lshlrev_b32 v40, 7, v40
    v_bfe_u32 v41, v1, 3, 2
    v_bfrev_b32 v41, v41
    v_lshrrev_b32 v41, 25, v41
    v_add_u32 v40, v40, v41
    v_and_b32 v41, 3, v1
    v_lshl_add_u32 v40, v41, 3, v40
    s_lshl_b32 s82, s65, 12
    s_add_u32 s82, s82, 64000
    v_add_u32 v40, s82, v40
    v_xor_b32 v41, 64, v40
    s_waitcnt vmcnt(0)
    ds_read_b64_tr_b16 v[44:45], v40 offset:0
    ds_read_b64_tr_b16 v[46:47], v40 offset:512
    ds_read_b64_tr_b16 v[48:49], v41 offset:0
    ds_read_b64_tr_b16 v[50:51], v41 offset:512
    ds_read_b64_tr_b16 v[52:53], v40 offset:2048
    ds_read_b64_tr_b16 v[54:55], v40 offset:2560
    ds_read_b64_tr_b16 v[56:57], v41 offset:2048
    ds_read_b64_tr_b16 v[58:59], v41 offset:2560
    s_mov_b32 s92, s80
    s_add_u32 s93, s80, 151552
    s_mov_b32 s94, s81
    s_add_u32 s95, s81, 151552
    s_waitcnt lgkmcnt(0)
    s_lshl_b32 s82, s67, 3
    s_lshl_b32 s83, s65, 1
    s_add_u32 s82, s82, s83
    s_mul_i32 s82, s82, 108
    s_lshl_b32 s83, s68, 2
    s_add_u32 s82, s82, s83
    s_lshl_b32 s82, s82, 10
    s_add_u32 s89, s82, 0
    s_cmp_lt_u32 s68, 27
    s_cselect_b32 s89, s89, 33554432
    s_add_u32 s90, s89, 110592
    s_branch k2_gemm
k1_compute:
    v_and_b32 v1, 63, v0
    s_and_b32 s82, s2, 7
    s_lshr_b32 s83, s2, 3
    s_and_b32 s67, s82, 1
    s_lshl_b32 s67, s67, 2
    s_and_b32 s84, s83, 3
    s_or_b32 s67, s67, s84
    s_lshr_b32 s85, s82, 1
    s_lshr_b32 s84, s83, 2
    s_mul_i32 s68, s85, 7
    s_add_u32 s68, s68, s84
    s_cmp_eq_u32 s68, 6
    s_cselect_b32 s68, 31, s68
    s_min_u32 s86, s85, 1
    s_sub_u32 s68, s68, s86
    s_add_u32 s85, s85, 27
    s_cmp_eq_u32 s84, 7
    s_cselect_b32 s68, s85, s68
    s_and_b32 s65, s64, 3
    s_lshr_b32 s66, s64, 3
    v_lshlrev_b32 v2, 4, v1
    s_setprio 3
    s_lshl_b32 s82, s67, 8
    s_lshl_b32 s83, s68, 3
    s_add_u32 s82, s82, s83
    s_add_u32 s82, s82, s64
    s_sub_u32 s81, s82, 4
    s_mul_i32 s80, s81, 1280
    v_lshlrev_b32 v159, 2, v1
    s_mov_b32 s6, 2621440
    s_mov_b32 s7, 0x20000
    s_waitcnt lgkmcnt(0)
    s_mov_b32 s4, s40
    s_mov_b32 s5, s41
    buffer_load_dwordx4 v[128:131], v2, s[4:7], s80 offen
    buffer_load_dword v132, v159, s[4:7], s80 offen offset:1024
    v_and_b32 v144, 31, v1
    v_lshrrev_b32 v145, 5, v1
    s_lshl_b32 s82, s65, 13
    v_lshlrev_b32 v148, 7, v144
    v_add_u32 v148, s82, v148
    v_bfe_u32 v149, v1, 1, 3
    v_xor_b32 v149, v149, v145
    v_bfe_u32 v150, v1, 2, 2
    v_lshl_add_u32 v150, v145, 3, v150
    v_bfe_u32 v151, v1, 3, 1
    v_xor_b32 v151, s66, v151
    v_lshlrev_b32 v151, 6, v151
    v_bfe_u32 v157, v1, 4, 1
    v_lshlrev_b32 v157, 5, v157
    v_and_b32 v158, 3, v1
    v_lshl_add_u32 v157, v158, 3, v157
    v_lshl_add_u32 v151, v150, 7, v151
    v_add_u32 v151, v151, v157
    s_add_u32 s82, s65, 0
    s_and_b32 s82, s82, 3
    s_lshl_b32 s83, s82, 1
    v_xor_b32 v158, s83, v149
    v_lshl_add_u32 v3, v158, 4, v148
    s_lshl_b32 s83, s82, 11
    s_add_u32 s83, s83, 32768
    v_add_u32 v7, s83, v151
    s_add_u32 s82, s65, 1
    s_and_b32 s82, s82, 3
    s_lshl_b32 s83, s82, 1
    v_xor_b32 v158, s83, v149
    v_lshl_add_u32 v4, v158, 4, v148
    s_lshl_b32 s83, s82, 11
    s_add_u32 s83, s83, 32768
    v_add_u32 v8, s83, v151
    s_add_u32 s82, s65, 2
    s_and_b32 s82, s82, 3
    s_lshl_b32 s83, s82, 1
    v_xor_b32 v158, s83, v149
    v_lshl_add_u32 v5, v158, 4, v148
    s_lshl_b32 s83, s82, 11
    s_add_u32 s83, s83, 32768
    v_add_u32 v9, s83, v151
    s_add_u32 s82, s65, 3
    s_and_b32 s82, s82, 3
    s_lshl_b32 s83, s82, 1
    v_xor_b32 v158, s83, v149
    v_lshl_add_u32 v6, v158, 4, v148
    s_lshl_b32 s83, s82, 11
    s_add_u32 s83, s83, 32768
    v_add_u32 v10, s83, v151
    s_lshl_b32 s82, s66, 11
    s_lshl_b32 s83, s65, 2
    s_add_u32 s82, s82, s83
    s_add_u32 s82, s82, 155136
    v_add_u32 v19, s82, v2
    v_mov_b32 v18, 0xffff0000
    v_mov_b32 v15, 0
    v_mov_b32 v16, 0
    v_mov_b32 v17, 0
    s_lshl_b32 s82, s66, 4
    s_add_u32 s82, s82, s83
    s_add_u32 s82, s82, 159232
    v_mov_b32 v11, s82
    ds_write_b32 v11, v17
    s_lshl_b32 s82, s64, 2
    s_add_u32 s82, s82, 159296
    v_mov_b32 v40, s82
    ds_write_b32 v40, v17
    v_and_b32 v41, 12, v159
    v_add_u32 v41, 159296, v41
    v_mov_b32 v42, 0
    s_lshl_b32 s82, s65, 8
    s_add_u32 s82, s82, 160256
    v_and_b32 v12, 31, v1
    v_lshlrev_b32 v12, 2, v12
    v_add_u32 v12, s82, v12
    v_mov_b32 v44, 0
    v_mov_b32 v45, 0
    v_mov_b32 v46, 0
    v_mov_b32 v47, 0
    v_mov_b32 v48, 0
    v_mov_b32 v49, 0
    v_mov_b32 v50, 0
    v_mov_b32 v51, 0
    v_mov_b32 v52, 0
    v_mov_b32 v53, 0
    v_mov_b32 v54, 0
    v_mov_b32 v55, 0
    v_mov_b32 v56, 0
    v_mov_b32 v57, 0
    v_mov_b32 v58, 0
    v_mov_b32 v59, 0
    v_mov_b32 v60, 0
    v_mov_b32 v61, 0
    v_mov_b32 v62, 0
    v_mov_b32 v63, 0
    v_mov_b32 v64, 0
    v_mov_b32 v65, 0
    v_mov_b32 v66, 0
    v_mov_b32 v67, 0
    v_mov_b32 v68, 0
    v_mov_b32 v69, 0
    v_mov_b32 v70, 0
    v_mov_b32 v71, 0
    v_mov_b32 v72, 0
    v_mov_b32 v73, 0
    v_mov_b32 v74, 0
    v_mov_b32 v75, 0
    v_mov_b32 v76, 0
    v_mov_b32 v77, 0
    v_mov_b32 v78, 0
    v_mov_b32 v79, 0
    v_mov_b32 v80, 0
    v_mov_b32 v81, 0
    v_mov_b32 v82, 0
    v_mov_b32 v83, 0
    v_mov_b32 v84, 0
    v_mov_b32 v85, 0
    v_mov_b32 v86, 0
    v_mov_b32 v87, 0
    v_mov_b32 v88, 0
    v_mov_b32 v89, 0
    v_mov_b32 v90, 0
    v_mov_b32 v91, 0
    v_mov_b32 v92, 0
    v_mov_b32 v93, 0
    v_mov_b32 v94, 0
    v_mov_b32 v95, 0
    v_mov_b32 v96, 0
    v_mov_b32 v97, 0
    v_mov_b32 v98, 0
    v_mov_b32 v99, 0
    v_mov_b32 v100, 0
    v_mov_b32 v101, 0
    v_mov_b32 v102, 0
    v_mov_b32 v103, 0
    v_mov_b32 v104, 0
    v_mov_b32 v105, 0
    v_mov_b32 v106, 0
    v_mov_b32 v107, 0
    v_mov_b32 v108, 0
    v_mov_b32 v109, 0
    v_mov_b32 v110, 0
    v_mov_b32 v111, 0
    v_mov_b32 v112, 0
    v_mov_b32 v113, 0
    v_mov_b32 v114, 0
    v_mov_b32 v115, 0
    v_mov_b32 v116, 0
    v_mov_b32 v117, 0
    v_mov_b32 v118, 0
    v_mov_b32 v119, 0
    v_mov_b32 v120, 0
    v_mov_b32 v121, 0
    v_mov_b32 v122, 0
    v_mov_b32 v123, 0
    v_mov_b32 v124, 0
    v_mov_b32 v125, 0
    v_mov_b32 v126, 0
    v_mov_b32 v127, 0
    s_mov_b32 s70, 0
    s_mov_b32 s71, 0
    s_mov_b32 s20, s62
    s_mov_b32 s21, s63
    s_mov_b32 s22, 33554432
    s_mov_b32 s23, 0x20000
    s_mov_b32 s24, s60
    s_mov_b32 s25, s61
    s_mov_b32 s26, 256
    s_mov_b32 s27, 0x20000
    s_mov_b32 s73, 1
    s_mov_b32 s77, 9
    s_getpc_b64 s[74:75]
k1_pc:
    s_add_u32 s74, s74, k2_gemm-k1_pc
    s_addc_u32 s75, s75, 0
    s_sub_u32 s82, s64, 4
    s_lshl_b32 s82, s82, 11
    v_lshlrev_b32 v165, 7, v1
    v_and_b32 v165, 0x7ff, v165
    v_add_u32 v165, s82, v165
    v_min_u32 v165, k2_fb0-k2_gemm, v165
    global_load_dword v166, v165, s[74:75]
    s_waitcnt vmcnt(1)
    v_lshlrev_b32 v133, 16, v128
    v_and_b32 v134, v18, v128
    v_lshlrev_b32 v135, 16, v129
    v_and_b32 v136, v18, v129
    v_lshlrev_b32 v137, 16, v130
    v_and_b32 v138, v18, v130
    v_lshlrev_b32 v139, 16, v131
    v_and_b32 v140, v18, v131
    v_lshlrev_b32 v141, 16, v132
    v_and_b32 v142, v18, v132
    v_add_f32 v148, v133, v134
    v_add_f32 v150, v135, v136
    v_add_f32 v148, v148, v137
    v_add_f32 v150, v150, v138
    v_add_f32 v148, v148, v139
    v_add_f32 v150, v150, v140
    v_add_f32 v148, v148, v141
    v_add_f32 v150, v150, v142
    v_add_f32 v148, v148, v150
    s_nop 1
    v_add_f32_dpp v148, v148, v148 row_shr:1 row_mask:0xf bank_mask:0xf
    s_nop 1
    v_add_f32_dpp v148, v148, v148 row_shr:2 row_mask:0xf bank_mask:0xf
    s_nop 1
    v_add_f32_dpp v148, v148, v148 row_shr:4 row_mask:0xf bank_mask:0xf
    s_nop 1
    v_add_f32_dpp v148, v148, v148 row_shr:8 row_mask:0xf bank_mask:0xf
    s_nop 1
    v_add_f32_dpp v148, v148, v148 row_bcast:15 row_mask:0xa bank_mask:0xf
    s_nop 1
    v_add_f32_dpp v148, v148, v148 row_bcast:31 row_mask:0xc bank_mask:0xf
    v_mul_f32 v148, 0x3acccccd, v148
    s_nop 0
    v_readlane_b32 s82, v148, 63
    s_nop 1
    v_mov_b32 v149, s82
    v_sub_f32 v133, v133, v149
    v_sub_f32 v134, v134, v149
    v_sub_f32 v135, v135, v149
    v_sub_f32 v136, v136, v149
    v_sub_f32 v137, v137, v149
    v_sub_f32 v138, v138, v149
    v_sub_f32 v139, v139, v149
    v_sub_f32 v140, v140, v149
    v_sub_f32 v141, v141, v149
    v_sub_f32 v142, v142, v149
    v_mul_f32 v148, v133, v133
    v_mul_f32 v150, v134, v134
    v_fmac_f32 v148, v135, v135
    v_fmac_f32 v150, v136, v136
    v_fmac_f32 v148, v137, v137
    v_fmac_f32 v150, v138, v138
    v_fmac_f32 v148, v139, v139
    v_fmac_f32 v150, v140, v140
    v_fmac_f32 v148, v141, v141
    v_fmac_f32 v150, v142, v142
    v_add_f32 v148, v148, v150
    s_nop 1
    v_add_f32_dpp v148, v148, v148 row_shr:1 row_mask:0xf bank_mask:0xf
    s_nop 1
    v_add_f32_dpp v148, v148, v148 row_shr:2 row_mask:0xf bank_mask:0xf
    s_nop 1
    v_add_f32_dpp v148, v148, v148 row_shr:4 row_mask:0xf bank_mask:0xf
    s_nop 1
    v_add_f32_dpp v148, v148, v148 row_shr:8 row_mask:0xf bank_mask:0xf
    s_nop 1
    v_add_f32_dpp v148, v148, v148 row_bcast:15 row_mask:0xa bank_mask:0xf
    s_nop 1
    v_add_f32_dpp v148, v148, v148 row_bcast:31 row_mask:0xc bank_mask:0xf
    v_mul_f32 v148, 0x3acccccd, v148
    v_cvt_pk_bf16_f32 v133, v149, v148
    v_lshlrev_b32 v153, 16, v133
    v_and_b32 v148, v18, v133
    v_add_f32 v148, 0x3727c5ac, v148
    v_cvt_pk_bf16_f32 v148, v148, v148
    v_and_b32 v148, v18, v148
    v_sqrt_f32 v148, v148
    s_lshr_b32 s82, s81, 3
    v_cvt_pk_bf16_f32 v148, v148, v148
    v_and_b32 v148, v18, v148
    v_rcp_f32 v152, v148
    s_lshl_b32 s82, s82, 7
    s_and_b32 s83, s81, 7
    s_lshl_b32 s83, s83, 3
    s_add_u32 s82, s82, s83
    s_add_u32 s82, s82, 14680064
    s_lshl_b32 s84, s2, 7
    s_add_u32 s84, s84, 14811136
    s_cmp_eq_u32 s64, 4
    s_cselect_b32 s84, s84, 33554432
    v_lshrrev_b32 v135, 3, v1
    v_lshlrev_b32 v135, 15, v135
    v_and_b32 v136, 7, v1
    v_lshl_add_u32 v135, v136, 4, v135
    s_mov_b64 exec, 0xffffff
    buffer_store_dwordx4 v[60:63], v135, s[20:23], s84 offen sc1
    s_mov_b32 exec_lo, 0
    s_mov_b32 exec_hi, 0x80000000
    buffer_store_dwordx2 v[152:153], v17, s[20:23], s82 offen sc1
    s_mov_b64 exec, -1
    s_setprio 0
    s_waitcnt lgkmcnt(0)
    s_barrier
    ds_read_b128 v[24:27], v3
    ds_read_b64_tr_b16 v[32:33], v7
    ds_read_b64_tr_b16 v[34:35], v7 offset:512
    ds_read_b128 v[28:31], v3 offset:4096
    ds_read_b64_tr_b16 v[36:37], v7 offset:8192
    ds_read_b64_tr_b16 v[38:39], v7 offset:8704
    ds_read_b128 v[144:147], v4
    ds_read_b64_tr_b16 v[152:153], v8
    ds_read_b64_tr_b16 v[154:155], v8 offset:512
    ds_read_b128 v[148:151], v4 offset:4096
    ds_read_b64_tr_b16 v[156:157], v8 offset:8192
    ds_read_b64_tr_b16 v[158:159], v8 offset:8704
    s_mul_i32 s73, s68, 32
    s_lshr_b32 s73, s73, 7
    s_mul_i32 s73, s73, 4
    s_sub_u32 s73, s68, s73
    s_add_u32 s73, s73, 1
    s_cmp_eq_u32 s64, 8
    s_cselect_b32 s73, s73, 15
    s_waitcnt vmcnt(0)
    s_branch k1_mid
k1_topP:
    s_waitcnt lgkmcnt(0)
    s_barrier
    v_mfma_f32_32x32x16_bf16 v[64:79], v[52:55], v[44:47], v[64:79]
    ds_read_b128 v[24:27], v3
    ds_read_b64_tr_b16 v[32:33], v7
    v_mfma_f32_32x32x16_bf16 v[80:95], v[52:55], v[48:51], v[80:95]
    ds_read_b64_tr_b16 v[34:35], v7 offset:512
    ds_read_b128 v[28:31], v3 offset:4096
    v_mfma_f32_32x32x16_bf16 v[96:111], v[56:59], v[44:47], v[96:111]
    ds_read_b64_tr_b16 v[36:37], v7 offset:8192
    ds_read_b64_tr_b16 v[38:39], v7 offset:8704
    v_mfma_f32_32x32x16_bf16 v[112:127], v[56:59], v[48:51], v[112:127]
    v_mfma_f32_32x32x16_bf16 v[64:79], v[136:139], v[128:131], v[64:79]
    ds_read_b128 v[144:147], v4
    ds_read_b64_tr_b16 v[152:153], v8
    v_mfma_f32_32x32x16_bf16 v[80:95], v[136:139], v[132:135], v[80:95]
    ds_read_b64_tr_b16 v[154:155], v8 offset:512
    ds_read_b128 v[148:151], v4 offset:4096
    v_mfma_f32_32x32x16_bf16 v[96:111], v[140:143], v[128:131], v[96:111]
    ds_read_b64_tr_b16 v[156:157], v8 offset:8192
    ds_read_b64_tr_b16 v[158:159], v8 offset:8704
    v_mfma_f32_32x32x16_bf16 v[112:127], v[140:143], v[132:135], v[112:127]
    s_cmp_eq_u32 s70, s73
    s_cbranch_scc1 x_L37
x_L37r:
k1_mid:
    s_waitcnt lgkmcnt(6)
    v_mfma_f32_32x32x16_bf16 v[64:79], v[32:35], v[24:27], v[64:79]
    ds_read_b128 v[44:47], v5
    ds_read_b64_tr_b16 v[52:53], v9
    v_lshlrev_b32 v40, 16, v32
    v_and_b32 v41, v18, v32
    v_add_f32 v40, v40, v41
    v_add_f32 v15, v15, v40
    v_lshlrev_b32 v42, 16, v33
    v_and_b32 v43, v18, v33
    v_add_f32 v42, v42, v43
    v_add_f32 v15, v15, v42
    v_mfma_f32_32x32x16_bf16 v[80:95], v[32:35], v[28:31], v[80:95]
    ds_read_b64_tr_b16 v[54:55], v9 offset:512
    ds_read_b128 v[48:51], v5 offset:4096
    v_lshlrev_b32 v40, 16, v34
    v_and_b32 v41, v18, v34
    v_add_f32 v40, v40, v41
    v_add_f32 v15, v15, v40
    v_lshlrev_b32 v42, 16, v35
    v_and_b32 v43, v18, v35
    v_add_f32 v42, v42, v43
    v_add_f32 v15, v15, v42
    v_mfma_f32_32x32x16_bf16 v[96:111], v[36:39], v[24:27], v[96:111]
    ds_read_b64_tr_b16 v[56:57], v9 offset:8192
    ds_read_b64_tr_b16 v[58:59], v9 offset:8704
    v_lshlrev_b32 v40, 16, v36
    v_and_b32 v41, v18, v36
    v_add_f32 v40, v40, v41
    v_add_f32 v16, v16, v40
    v_lshlrev_b32 v42, 16, v37
    v_and_b32 v43, v18, v37
    v_add_f32 v42, v42, v43
    v_add_f32 v16, v16, v42
    v_mfma_f32_32x32x16_bf16 v[112:127], v[36:39], v[28:31], v[112:127]
    v_lshlrev_b32 v40, 16, v38
    v_and_b32 v41, v18, v38
    v_add_f32 v40, v40, v41
    v_add_f32 v16, v16, v40
    v_lshlrev_b32 v42, 16, v39
    v_and_b32 v43, v18, v39
    v_add_f32 v42, v42, v43
    v_add_f32 v16, v16, v42
    s_waitcnt lgkmcnt(6)
    v_mfma_f32_32x32x16_bf16 v[64:79], v[152:155], v[144:147], v[64:79]
    ds_read_b128 v[128:131], v6
    ds_read_b64_tr_b16 v[136:137], v10
    s_add_u32 s72, s71, 51712
    s_cmp_eq_u32 s72, 155136
    s_cselect_b32 s82, 0, s72
    s_sub_u32 s72, s82, s71
    s_mov_b32 s71, s82
    v_add_u32 v3, s72, v3
    v_add_u32 v7, s72, v7
    v_mfma_f32_32x32x16_bf16 v[80:95], v[152:155], v[148:151], v[80:95]
    ds_read_b64_tr_b16 v[138:139], v10 offset:512
    ds_read_b128 v[132:135], v6 offset:4096
    v_add_u32 v4, s72, v4
    v_add_u32 v8, s72, v8
    v_add_u32 v5, s72, v5
    v_add_u32 v9, s72, v9
    s_cmp_eq_u32 s70, 9
    s_cbranch_scc1 x_L38
x_L38r:
    v_mfma_f32_32x32x16_bf16 v[96:111], v[156:159], v[144:147], v[96:111]
    ds_read_b64_tr_b16 v[140:141], v10 offset:8192
    ds_read_b64_tr_b16 v[142:143], v10 offset:8704
    v_mfma_f32_32x32x16_bf16 v[112:127], v[156:159], v[148:151], v[112:127]
    v_add_u32 v6, s72, v6
    v_add_u32 v10, s72, v10
    s_add_u32 s70, s70, 1
    s_cmp_lt_u32 s70, 10
    s_cbranch_scc1 k1_topP
    s_waitcnt lgkmcnt(6)
    v_mfma_f32_32x32x16_bf16 v[64:79], v[52:55], v[44:47], v[64:79]
    v_mfma_f32_32x32x16_bf16 v[80:95], v[52:55], v[48:51], v[80:95]
    v_mfma_f32_32x32x16_bf16 v[96:111], v[56:59], v[44:47], v[96:111]
    v_mfma_f32_32x32x16_bf16 v[112:127], v[56:59], v[48:51], v[112:127]
    s_lshl_b32 s83, s65, 2
    v_subrev_u32 v19, s83, v19
    v_subrev_u32 v11, s83, v11
    ds_read_b32 v20, v12
    ds_read_b32 v21, v12 offset:128
    ds_read_b32 v22, v12 offset:1024
    ds_read_b32 v23, v12 offset:1152
    ds_read_b128 v[152:155], v11
    ds_read_b128 v[144:147], v19
    ds_read_b128 v[148:151], v19 offset:1024
    s_waitcnt lgkmcnt(7)
    v_mfma_f32_32x32x16_bf16 v[64:79], v[136:139], v[128:131], v[64:79]
    s_mov_b32 s83, 0x07060302
    s_waitcnt lgkmcnt(5)
    v_xor_b32 v20, 0x80000000, v20
    v_perm_b32 v24, v20, v20, s83
    v_mov_b32 v25, v24
    v_mov_b32 v26, 0
    v_mov_b32 v27, 0
    v_mfma_f32_32x32x16_bf16 v[80:95], v[136:139], v[132:135], v[80:95]
    v_xor_b32 v21, 0x80000000, v21
    v_perm_b32 v28, v21, v21, s83
    v_mov_b32 v29, v28
    v_mov_b32 v30, 0
    v_mov_b32 v31, 0
    v_mfma_f32_32x32x16_bf16 v[96:111], v[140:143], v[128:131], v[96:111]
k1_csw:
    s_waitcnt lgkmcnt(0)
    v_and_b32 v152, v152, v153
    v_and_b32 v154, v154, v155
    v_and_b32 v152, v152, v154
    v_cmp_ne_u32 vcc, 1, v152
    s_nop 0
    s_cbranch_vccnz k1_csr
    v_mfma_f32_32x32x16_bf16 v[112:127], v[140:143], v[132:135], v[112:127]
    v_add_f32 v144, v144, v145
    v_add_f32 v146, v146, v147
    v_add_f32 v144, v144, v146
    v_and_b32 v145, v18, v144
    v_sub_f32 v146, v144, v145
    v_and_b32 v147, v18, v146
    v_perm_b32 v32, v147, v145, s83
    v_sub_f32 v146, v146, v147
    v_lshrrev_b32 v33, 16, v146
    v_mov_b32 v34, 0
    v_mov_b32 v35, 0
    v_add_f32 v148, v148, v149
    v_add_f32 v150, v150, v151
    v_add_f32 v148, v148, v150
    v_and_b32 v149, v18, v148
    v_sub_f32 v150, v148, v149
    v_and_b32 v151, v18, v150
    v_perm_b32 v36, v151, v149, s83
    v_sub_f32 v150, v150, v151
    v_lshrrev_b32 v37, 16, v150
    v_mov_b32 v38, 0
    v_mov_b32 v39, 0
    s_nop 1
    v_mfma_f32_32x32x16_bf16 v[64:79], v[32:35], v[24:27], v[64:79]
    v_mfma_f32_32x32x16_bf16 v[80:95], v[32:35], v[28:31], v[80:95]
    v_mfma_f32_32x32x16_bf16 v[96:111], v[36:39], v[24:27], v[96:111]
    v_mfma_f32_32x32x16_bf16 v[112:127], v[36:39], v[28:31], v[112:127]
    s_cmp_ge_u32 s68, 27
    s_cbranch_scc1 k1_epiq
    s_lshl_b32 s82, s65, 13
    s_lshl_b32 s83, s66, 12
    s_add_u32 s82, s82, s83
    s_add_u32 s82, s82, 110592
    v_add_u32 v160, s82, v2
    s_mov_b32 s76, 33554432
    s_nop 3
    v_mul_f32 v22, v22, v22
    v_mul_f32 v22, 0.5, v22
    v_mul_f32 v23, v23, v23
    v_mul_f32 v23, 0.5, v23
    v_add_f32 v64, v64, |v64|
    v_mul_f32 v96, v96, v22
    v_add_f32 v65, v65, |v65|
    v_mul_f32 v97, v97, v22
    v_add_f32 v66, v66, |v66|
    v_mul_f32 v98, v98, v22
    v_add_f32 v67, v67, |v67|
    v_mul_f32 v99, v99, v22
    v_add_f32 v68, v68, |v68|
    v_mul_f32 v100, v100, v22
    v_add_f32 v69, v69, |v69|
    v_mul_f32 v101, v101, v22
    v_add_f32 v70, v70, |v70|
    v_mul_f32 v102, v102, v22
    v_add_f32 v71, v71, |v71|
    v_mul_f32 v103, v103, v22
    v_mul_f32 v64, v64, v96
    v_mul_f32 v65, v65, v97
    v_mul_f32 v66, v66, v98
    v_mul_f32 v67, v67, v99
    v_mul_f32 v68, v68, v100
    v_mul_f32 v69, v69, v101
    v_mul_f32 v70, v70, v102
    v_mul_f32 v71, v71, v103
    v_cvt_pk_bf16_f32 v144, v64, v65
    v_cvt_pk_bf16_f32 v145, v66, v67
    v_cvt_pk_bf16_f32 v146, v68, v69
    v_cvt_pk_bf16_f32 v147, v70, v71
    ds_write_b128 v160, v[144:147] offset:0
    v_add_f32 v72, v72, |v72|
    v_mul_f32 v104, v104, v22
    v_add_f32 v73, v73, |v73|
    v_mul_f32 v105, v105, v22
    v_add_f32 v74, v74, |v74|
    v_mul_f32 v106, v106, v22
    v_add_f32 v75, v75, |v75|
    v_mul_f32 v107, v107, v22
    v_add_f32 v76, v76, |v76|
    v_mul_f32 v108, v108, v22
    v_add_f32 v77, v77, |v77|
    v_mul_f32 v109, v109, v22
    v_add_f32 v78, v78, |v78|
    v_mul_f32 v110, v110, v22
    v_add_f32 v79, v79, |v79|
    v_mul_f32 v111, v111, v22
    v_mul_f32 v72, v72, v104
    v_mul_f32 v73, v73, v105
    v_mul_f32 v74, v74, v106
    v_mul_f32 v75, v75, v107
    v_mul_f32 v76, v76, v108
    v_mul_f32 v77, v77, v109
    v_mul_f32 v78, v78, v110
    v_mul_f32 v79, v79, v111
    v_cvt_pk_bf16_f32 v148, v72, v73
    v_cvt_pk_bf16_f32 v149, v74, v75
    v_cvt_pk_bf16_f32 v150, v76, v77
    v_cvt_pk_bf16_f32 v151, v78, v79
    ds_write_b128 v160, v[148:151] offset:1024
    v_add_f32 v80, v80, |v80|
    v_mul_f32 v112, v112, v23
    v_add_f32 v81, v81, |v81|
    v_mul_f32 v113, v113, v23
    v_add_f32 v82, v82, |v82|
    v_mul_f32 v114, v114, v23
    v_add_f32 v83, v83, |v83|
    v_mul_f32 v115, v115, v23
    v_add_f32 v84, v84, |v84|
    v_mul_f32 v116, v116, v23
    v_add_f32 v85, v85, |v85|
    v_mul_f32 v117, v117, v23
    v_add_f32 v86, v86, |v86|
    v_mul_f32 v118, v118, v23
    v_add_f32 v87, v87, |v87|
    v_mul_f32 v119, v119, v23
    v_mul_f32 v80, v80, v112
    v_mul_f32 v81, v81, v113
    v_mul_f32 v82, v82, v114
    v_mul_f32 v83, v83, v115
    v_mul_f32 v84, v84, v116
    v_mul_f32 v85, v85, v117
    v_mul_f32 v86, v86, v118
    v_mul_f32 v87, v87, v119
    v_cvt_pk_bf16_f32 v152, v80, v81
    v_cvt_pk_bf16_f32 v153, v82, v83
    v_cvt_pk_bf16_f32 v154, v84, v85
    v_cvt_pk_bf16_f32 v155, v86, v87
    ds_write_b128 v160, v[152:155] offset:2048
    v_add_f32 v88, v88, |v88|
    v_mul_f32 v120, v120, v23
    v_add_f32 v89, v89, |v89|
    v_mul_f32 v121, v121, v23
    v_add_f32 v90, v90, |v90|
    v_mul_f32 v122, v122, v23
    v_add_f32 v91, v91, |v91|
    v_mul_f32 v123, v123, v23
    v_add_f32 v92, v92, |v92|
    v_mul_f32 v124, v124, v23
    v_add_f32 v93, v93, |v93|
    v_mul_f32 v125, v125, v23
    v_add_f32 v94, v94, |v94|
    v_mul_f32 v126, v126, v23
    v_add_f32 v95, v95, |v95|
    v_mul_f32 v127, v127, v23
    v_mul_f32 v88, v88, v120
    v_mul_f32 v89, v89, v121
    v_mul_f32 v90, v90, v122
    v_mul_f32 v91, v91, v123
    v_mul_f32 v92, v92, v124
    v_mul_f32 v93, v93, v125
    v_mul_f32 v94, v94, v126
    v_mul_f32 v95, v95, v127
    v_cvt_pk_bf16_f32 v156, v88, v89
    v_cvt_pk_bf16_f32 v157, v90, v91
    v_cvt_pk_bf16_f32 v158, v92, v93
    v_cvt_pk_bf16_f32 v159, v94, v95
    ds_write_b128 v160, v[156:159] offset:3072
    s_branch k2_attn
k1_epiq:
    s_lshl_b32 s82, s67, 3
    s_lshl_b32 s83, s65, 1
    s_add_u32 s82, s82, s83
    s_mul_i32 s82, s82, 40960
    s_sub_u32 s83, s68, 27
    s_lshl_b32 s83, s83, 13
    s_add_u32 s82, s82, s83
    s_lshl_b32 s83, s66, 11
    s_add_u32 s82, s82, s83
    s_add_u32 s82, s82, 7340032
    s_add_u32 s83, s82, 40960
    s_add_u32 s84, s82, 4096
    s_add_u32 s85, s83, 4096
    v_mul_f32 v153, 0x3ea52b5c, v22
    v_mul_f32 v154, 0x3ea52b5c, v23
    v_mul_f32 v64, v64, v153
    v_mul_f32 v65, v65, v153
    v_mul_f32 v66, v66, v153
    v_mul_f32 v67, v67, v153
    v_mul_f32 v68, v68, v153
    v_mul_f32 v69, v69, v153
    v_mul_f32 v70, v70, v153
    v_mul_f32 v71, v71, v153
    v_cvt_pk_bf16_f32 v64, v64, v65
    v_cvt_pk_bf16_f32 v65, v66, v67
    v_cvt_pk_bf16_f32 v66, v68, v69
    v_cvt_pk_bf16_f32 v67, v70, v71
    buffer_store_dwordx4 v[64:67], v2, s[20:23], s82 offen offset:0 sc0 sc1
    v_mul_f32 v72, v72, v153
    v_mul_f32 v73, v73, v153
    v_mul_f32 v74, v74, v153
    v_mul_f32 v75, v75, v153
    v_mul_f32 v76, v76, v153
    v_mul_f32 v77, v77, v153
    v_mul_f32 v78, v78, v153
    v_mul_f32 v79, v79, v153
    v_cvt_pk_bf16_f32 v72, v72, v73
    v_cvt_pk_bf16_f32 v73, v74, v75
    v_cvt_pk_bf16_f32 v74, v76, v77
    v_cvt_pk_bf16_f32 v75, v78, v79
    buffer_store_dwordx4 v[72:75], v2, s[20:23], s82 offen offset:1024 sc0 sc1
    v_mul_f32 v80, v80, v154
    v_mul_f32 v81, v81, v154
    v_mul_f32 v82, v82, v154
    v_mul_f32 v83, v83, v154
    v_mul_f32 v84, v84, v154
    v_mul_f32 v85, v85, v154
    v_mul_f32 v86, v86, v154
    v_mul_f32 v87, v87, v154
    v_cvt_pk_bf16_f32 v80, v80, v81
    v_cvt_pk_bf16_f32 v81, v82, v83
    v_cvt_pk_bf16_f32 v82, v84, v85
    v_cvt_pk_bf16_f32 v83, v86, v87
    buffer_store_dwordx4 v[80:83], v2, s[20:23], s83 offen offset:0 sc0 sc1
    v_mul_f32 v88, v88, v154
    v_mul_f32 v89, v89, v154
    v_mul_f32 v90, v90, v154
    v_mul_f32 v91, v91, v154
    v_mul_f32 v92, v92, v154
    v_mul_f32 v93, v93, v154
    v_mul_f32 v94, v94, v154
    v_mul_f32 v95, v95, v154
    v_cvt_pk_bf16_f32 v88, v88, v89
    v_cvt_pk_bf16_f32 v89, v90, v91
    v_cvt_pk_bf16_f32 v90, v92, v93
    v_cvt_pk_bf16_f32 v91, v94, v95
    buffer_store_dwordx4 v[88:91], v2, s[20:23], s83 offen offset:1024 sc0 sc1
    v_mul_f32 v96, v96, v153
    v_mul_f32 v97, v97, v153
    v_mul_f32 v98, v98, v153
    v_mul_f32 v99, v99, v153
    v_mul_f32 v100, v100, v153
    v_mul_f32 v101, v101, v153
    v_mul_f32 v102, v102, v153
    v_mul_f32 v103, v103, v153
    v_cvt_pk_bf16_f32 v96, v96, v97
    v_cvt_pk_bf16_f32 v97, v98, v99
    v_cvt_pk_bf16_f32 v98, v100, v101
    v_cvt_pk_bf16_f32 v99, v102, v103
    buffer_store_dwordx4 v[96:99], v2, s[20:23], s84 offen offset:0 sc0 sc1
    v_mul_f32 v104, v104, v153
    v_mul_f32 v105, v105, v153
    v_mul_f32 v106, v106, v153
    v_mul_f32 v107, v107, v153
    v_mul_f32 v108, v108, v153
    v_mul_f32 v109, v109, v153
    v_mul_f32 v110, v110, v153
    v_mul_f32 v111, v111, v153
    v_cvt_pk_bf16_f32 v104, v104, v105
    v_cvt_pk_bf16_f32 v105, v106, v107
    v_cvt_pk_bf16_f32 v106, v108, v109
    v_cvt_pk_bf16_f32 v107, v110, v111
    buffer_store_dwordx4 v[104:107], v2, s[20:23], s84 offen offset:1024 sc0 sc1
    v_mul_f32 v112, v112, v154
    v_mul_f32 v113, v113, v154
    v_mul_f32 v114, v114, v154
    v_mul_f32 v115, v115, v154
    v_mul_f32 v116, v116, v154
    v_mul_f32 v117, v117, v154
    v_mul_f32 v118, v118, v154
    v_mul_f32 v119, v119, v154
    v_cvt_pk_bf16_f32 v112, v112, v113
    v_cvt_pk_bf16_f32 v113, v114, v115
    v_cvt_pk_bf16_f32 v114, v116, v117
    v_cvt_pk_bf16_f32 v115, v118, v119
    buffer_store_dwordx4 v[112:115], v2, s[20:23], s85 offen offset:0 sc0 sc1
    v_mul_f32 v120, v120, v154
    v_mul_f32 v121, v121, v154
    v_mul_f32 v122, v122, v154
    v_mul_f32 v123, v123, v154
    v_mul_f32 v124, v124, v154
    v_mul_f32 v125, v125, v154
    v_mul_f32 v126, v126, v154
    v_mul_f32 v127, v127, v154
    v_cvt_pk_bf16_f32 v120, v120, v121
    v_cvt_pk_bf16_f32 v121, v122, v123
    v_cvt_pk_bf16_f32 v122, v124, v125
    v_cvt_pk_bf16_f32 v123, v126, v127
    buffer_store_dwordx4 v[120:123], v2, s[20:23], s85 offen offset:1024 sc0 sc1
    s_lshl_b32 s82, s67, 2
    s_add_u32 s82, s82, s65
    s_mul_i32 s82, s82, 10
    s_sub_u32 s83, s68, 27
    s_lshl_b32 s83, s83, 1
    s_add_u32 s83, s83, s66
    s_add_u32 s82, s82, s83
    s_lshl_b32 s82, s82, 7
    s_add_u32 s76, s82, 14811136
    s_branch k2_attn
x_L37:
    s_cmp_lg_u32 s70, 99
    s_cbranch_scc1 x_L37f
    s_and_b32 s73, s68, 3
    s_add_u32 s73, s73, 2
    s_cmp_eq_u32 s64, 8
    s_cselect_b32 s73, s73, 15
    s_waitcnt vmcnt(0)
    s_branch x_L37r
x_L37f:
    s_lshl_b32 s82, s67, 5
    v_mov_b32 v60, s82
    s_lshl_b32 s83, 1, s68
    v_mov_b32 v61, s83
    s_mov_b64 exec, 1
    buffer_atomic_or v61, v60, s[24:27], 0 offen sc1
    s_mov_b64 exec, -1
    s_branch x_L37r
x_L38:
    ds_write_b32 v19, v15
    ds_write_b32 v19, v16 offset:1024
    v_mov_b32 v60, 1
    ds_write_b32 v11, v60
    s_branch x_L38r
k1_csr:
    ds_read_b128 v[152:155], v11
    ds_read_b128 v[144:147], v19
    ds_read_b128 v[148:151], v19 offset:1024
    s_branch k1_csw
k2_gemm:
    s_setprio 3
    s_and_b32 s82, s2, 7
    s_lshr_b32 s83, s2, 3
    s_lshl_b32 s65, s82, 3
    s_lshr_b32 s84, s83, 2
    s_add_u32 s65, s65, s84
    s_and_b32 s66, s83, 3
    s_and_b32 s67, s64, 3
    s_lshl_b32 s82, s67, 13
    s_add_u32 s82, s82, 110592
    v_add_u32 v3, s82, v2
    v_mov_b32 v100, 0
    v_mov_b32 v101, 1
    v_lshlrev_b32 v102, 2, v1
    s_barrier
    ds_write_b32 v102, v100
    s_lshl_b32 s82, s67, 2
    v_mov_b32 v102, s82
    ds_read_b128 v[116:119], v3 offset:0
    ds_read_b128 v[120:123], v3 offset:1024
    ds_read_b128 v[124:127], v3 offset:2048
    ds_read_b128 v[128:131], v3 offset:3072
    ds_read_b128 v[132:135], v3 offset:4096
    ds_read_b128 v[136:139], v3 offset:5120
    ds_read_b128 v[140:143], v3 offset:6144
    ds_read_b128 v[144:147], v3 offset:7168
    s_and_b32 s91, s2, 7
    s_lshl_b32 s91, s91, 12
    s_cmp_lg_u32 s64, 1
    s_cbranch_scc1 k2_nopoll
    v_and_b32 v3, 31, v1
    v_lshlrev_b32 v3, 7, v3
    s_add_u32 s85, s91, 14852096
    s_mov_b32 s86, 0x40000
x_L39:
    buffer_load_dwordx4 v[4:7], v3, s[20:23], s85 offen sc1
    s_waitcnt vmcnt(0)
    v_and_b32 v8, v4, v5
    v_and_b32 v9, v6, v7
    v_and_b32 v8, v8, v9
    v_and_b32 v8, 1, v8
    v_cmp_ne_u32 vcc, 1, v8
    s_sub_u32 s86, s86, 1
    s_cbranch_vccz x_L39x
    s_sleep 4
    s_cbranch_scc0 x_L39
x_L39x:
    v_max3_f32 v4, v4, v5, v6
    v_max_f32 v4, v4, v7
    s_nop 1
    v_max_f32_dpp v4, v4, v4 row_shr:1 row_mask:0xf bank_mask:0xf
    s_nop 1
    v_max_f32_dpp v4, v4, v4 row_shr:2 row_mask:0xf bank_mask:0xf
    s_nop 1
    v_max_f32_dpp v4, v4, v4 row_shr:4 row_mask:0xf bank_mask:0xf
    s_nop 1
    v_max_f32_dpp v4, v4, v4 row_shr:8 row_mask:0xf bank_mask:0xf
    v_mov_b32 v5, 80384
    v_or_b32 v4, 1, v4
    s_mov_b64 exec, 0x8000
    ds_write_b32 v5, v4
    s_mov_b64 exec, -1
k2_nopoll:
    s_cmp_lg_u32 s64, 2
    s_cbranch_scc1 k2_first
    s_mul_i32 s85, s66, 5
    v_min_u32 v3, 4, v1
    v_add_u32 v3, s85, v3
    v_lshrrev_b32 v4, 2, v3
    v_and_b32 v3, 1, v3
    v_lshl_add_u32 v3, v4, 1, v3
    v_lshlrev_b32 v3, 7, v3
    s_lshr_b32 s85, s65, 1
    s_mul_i32 s85, s85, 1280
    s_add_u32 s85, s85, 14811136
    s_mov_b32 s86, 0x40000
x_L40:
    buffer_load_dword v4, v3, s[20:23], s85 offen sc1
    s_waitcnt vmcnt(0)
    v_cmp_ne_u32 vcc, 1, v4
    s_sub_u32 s86, s86, 1
    s_cbranch_vccz x_L40x
    s_sleep 4
    s_cbranch_scc0 x_L40
x_L40x:
    s_branch k2_a0
k2_first:
    v_mov_b32 v5, 80384
    s_min_u32 s82, s64, 2
    s_lshl_b32 s82, s82, 13
    s_add_u32 s83, s82, 10485760
k2_kw:
    ds_read_b32 v4, v5
    s_waitcnt lgkmcnt(0)
    v_cmp_eq_u32 vcc, 0, v4
    s_sleep 1
    s_cbranch_vccnz k2_kw
    s_add_u32 m0, s82, 0
    s_add_u32 s84, s83, 0
    s_cmp_eq_u32 s64, 0
    s_cbranch_scc1 k2_skip0
    buffer_load_dwordx4 v2, s[20:23], s84 offen offset:0 sc1 lds
k2_skip0:
    buffer_load_dwordx4 v2, s[20:23], s84 offen offset:1024 sc1 lds
    buffer_load_dwordx4 v2, s[20:23], s84 offen offset:2048 sc1 lds
    buffer_load_dwordx4 v2, s[20:23], s84 offen offset:3072 sc1 lds
    s_add_u32 m0, s82, 81920
    s_add_u32 s84, s83, 81920
    buffer_load_dwordx4 v2, s[20:23], s84 offen offset:0 sc1 lds
    buffer_load_dwordx4 v2, s[20:23], s84 offen offset:1024 sc1 lds
    buffer_load_dwordx4 v2, s[20:23], s84 offen offset:2048 sc1 lds
    buffer_load_dwordx4 v2, s[20:23], s84 offen offset:3072 sc1 lds
    s_add_u32 m0, s82, 4096
    s_add_u32 s84, s83, 4096
    buffer_load_dwordx4 v2, s[20:23], s84 offen offset:0 sc1 lds
    buffer_load_dwordx4 v2, s[20:23], s84 offen offset:1024 sc1 lds
    buffer_load_dwordx4 v2, s[20:23], s84 offen offset:2048 sc1 lds
    buffer_load_dwordx4 v2, s[20:23], s84 offen offset:3072 sc1 lds
    s_add_u32 m0, s82, 86016
    s_add_u32 s84, s83, 86016
    buffer_load_dwordx4 v2, s[20:23], s84 offen offset:0 sc1 lds
    buffer_load_dwordx4 v2, s[20:23], s84 offen offset:1024 sc1 lds
    buffer_load_dwordx4 v2, s[20:23], s84 offen offset:2048 sc1 lds
    buffer_load_dwordx4 v2, s[20:23], s84 offen offset:3072 sc1 lds
k2_a0:
    s_waitcnt lgkmcnt(0)
    s_barrier
    v_mov_b32 v4, 0
    v_mov_b32 v5, 0
    v_mov_b32 v6, 0
    v_mov_b32 v7, 0
    v_mov_b32 v8, 0
    v_mov_b32 v9, 0
    v_mov_b32 v10, 0
    v_mov_b32 v11, 0
    v_mov_b32 v12, 0
    v_mov_b32 v13, 0
    v_mov_b32 v14, 0
    v_mov_b32 v15, 0
    v_mov_b32 v16, 0
    v_mov_b32 v17, 0
    v_mov_b32 v18, 0
    v_mov_b32 v19, 0
    v_mov_b32 v20, 0
    v_mov_b32 v21, 0
    v_mov_b32 v22, 0
    v_mov_b32 v23, 0
    v_mov_b32 v24, 0
    v_mov_b32 v25, 0
    v_mov_b32 v26, 0
    v_mov_b32 v27, 0
    v_mov_b32 v28, 0
    v_mov_b32 v29, 0
    v_mov_b32 v30, 0
    v_mov_b32 v31, 0
    v_mov_b32 v32, 0
    v_mov_b32 v33, 0
    v_mov_b32 v34, 0
    v_mov_b32 v35, 0
    v_mov_b32 v36, 0
    v_mov_b32 v37, 0
    v_mov_b32 v38, 0
    v_mov_b32 v39, 0
    v_mov_b32 v40, 0
    v_mov_b32 v41, 0
    v_mov_b32 v42, 0
    v_mov_b32 v43, 0
    v_mov_b32 v60, 0
    v_mov_b32 v61, 0
    v_mov_b32 v62, 0
    v_mov_b32 v63, 0
    v_mov_b32 v64, 0
    v_mov_b32 v65, 0
    v_mov_b32 v66, 0
    v_mov_b32 v67, 0
    v_mov_b32 v68, 0
    v_mov_b32 v69, 0
    v_mov_b32 v70, 0
    v_mov_b32 v71, 0
    v_mov_b32 v72, 0
    v_mov_b32 v73, 0
    v_mov_b32 v74, 0
    v_mov_b32 v75, 0
    v_mov_b32 v76, 0
    v_mov_b32 v77, 0
    v_mov_b32 v78, 0
    v_mov_b32 v79, 0
    v_mov_b32 v80, 0
    v_mov_b32 v81, 0
    v_mov_b32 v82, 0
    v_mov_b32 v83, 0
    s_waitcnt vmcnt(0)
    s_barrier
    buffer_store_dwordx4 v[116:119], v2, s[20:23], s89 offen offset:0 sc0 sc1
    buffer_store_dwordx4 v[120:123], v2, s[20:23], s89 offen offset:1024 sc0 sc1
    buffer_store_dwordx4 v[124:127], v2, s[20:23], s90 offen offset:0 sc0 sc1
    buffer_store_dwordx4 v[128:131], v2, s[20:23], s90 offen offset:1024 sc0 sc1
    buffer_store_dwordx4 v[132:135], v2, s[20:23], s89 offen offset:2048 sc0 sc1
    buffer_store_dwordx4 v[136:139], v2, s[20:23], s89 offen offset:3072 sc0 sc1
    buffer_store_dwordx4 v[140:143], v2, s[20:23], s90 offen offset:2048 sc0 sc1
    buffer_store_dwordx4 v[144:147], v2, s[20:23], s90 offen offset:3072 sc0 sc1
    v_mov_b32 v104, -1
    v_mov_b32 v105, -1
    v_mov_b32 v106, -1
    v_mov_b32 v107, -1
    buffer_store_dwordx4 v[44:47], v2, s[20:23], s92 offen sc0 sc1
    buffer_store_dwordx4 v[48:51], v2, s[20:23], s93 offen sc0 sc1
    buffer_store_dwordx4 v[52:55], v2, s[20:23], s94 offen sc0 sc1
    buffer_store_dwordx4 v[56:59], v2, s[20:23], s95 offen sc0 sc1
    s_mul_i32 s82, s65, 40
    s_lshl_b32 s83, s66, 3
    s_lshl_b32 s84, s67, 1
    s_add_u32 s83, s83, s84
    s_add_u32 s83, s83, s82
    s_lshl_b32 s83, s83, 10
    s_add_u32 s83, s83, 15728640
    s_lshl_b32 s84, s66, 1
    s_add_u32 s84, s84, s67
    s_add_u32 s84, s84, s82
    s_lshl_b32 s84, s84, 10
    s_add_u32 s84, s84, 15761408
    s_cmp_lt_u32 s67, 2
    s_cselect_b32 s84, s84, 33554432
    buffer_store_dwordx4 v[104:107], v2, s[20:23], s83 offen sc0 sc1
    buffer_store_dwordx4 v[104:107], v2, s[20:23], s83 offen offset:1024 sc0 sc1
    buffer_store_dwordx4 v[104:107], v2, s[20:23], s84 offen sc0 sc1
    s_lshl_b32 s82, s67, 10
    s_add_u32 s83, s82, 10510336
    s_add_u32 s84, s83, 81920
    s_add_u32 m0, s82, 24576
    s_nop 0
    buffer_load_dwordx4 v2, s[20:23], s83 offen sc1 lds
    s_add_u32 m0, s82, 106496
    s_add_u32 s83, s83, 4096
    buffer_load_dwordx4 v2, s[20:23], s84 offen sc1 lds
    s_add_u32 s84, s84, 4096
    s_add_u32 m0, s82, 28672
    s_nop 0
    buffer_load_dwordx4 v2, s[20:23], s83 offen sc1 lds
    s_add_u32 m0, s82, 110592
    s_add_u32 s83, s83, 4096
    buffer_load_dwordx4 v2, s[20:23], s84 offen sc1 lds
    s_add_u32 s84, s84, 4096
    s_add_u32 m0, s82, 32768
    s_nop 0
    buffer_load_dwordx4 v2, s[20:23], s83 offen sc1 lds
    s_add_u32 m0, s82, 114688
    s_add_u32 s83, s83, 4096
    buffer_load_dwordx4 v2, s[20:23], s84 offen sc1 lds
    s_add_u32 s84, s84, 4096
    s_add_u32 m0, s82, 36864
    s_nop 0
    buffer_load_dwordx4 v2, s[20:23], s83 offen sc1 lds
    s_add_u32 m0, s82, 118784
    s_add_u32 s83, s83, 4096
    buffer_load_dwordx4 v2, s[20:23], s84 offen sc1 lds
    s_add_u32 s84, s84, 4096
    s_add_u32 m0, s82, 40960
    s_nop 0
    buffer_load_dwordx4 v2, s[20:23], s83 offen sc1 lds
    s_add_u32 m0, s82, 122880
    s_add_u32 s83, s83, 4096
    buffer_load_dwordx4 v2, s[20:23], s84 offen sc1 lds
    s_add_u32 s84, s84, 4096
    s_lshl_b32 s87, s2, 6
    s_add_u32 s87, s87, 14893056
    s_lshl_b32 s86, s67, 2
    s_add_u32 s85, s87, s86
    s_getreg_b32 s88, hwreg(HW_REG_XCC_ID, 0, 4)
    s_lshl_b32 s88, s88, 8
    s_or_b32 s88, s88, 1
    v_mov_b32 v103, s88
    s_waitcnt vmcnt(10)
    s_mov_b64 exec, 1
    buffer_store_dword v103, v100, s[20:23], s85 offen sc1
    s_mov_b64 exec, -1
    s_add_u32 m0, s82, 45056
    s_nop 0
    buffer_load_dwordx4 v2, s[20:23], s83 offen sc1 lds
    s_add_u32 m0, s82, 126976
    s_add_u32 s83, s83, 4096
    buffer_load_dwordx4 v2, s[20:23], s84 offen sc1 lds
    s_add_u32 s84, s84, 4096
    s_add_u32 m0, s82, 49152
    s_nop 0
    buffer_load_dwordx4 v2, s[20:23], s83 offen sc1 lds
    s_add_u32 m0, s82, 131072
    s_add_u32 s83, s83, 4096
    buffer_load_dwordx4 v2, s[20:23], s84 offen sc1 lds
    s_add_u32 s84, s84, 4096
    s_add_u32 m0, s82, 53248
    s_nop 0
    buffer_load_dwordx4 v2, s[20:23], s83 offen sc1 lds
    s_add_u32 m0, s82, 135168
    s_add_u32 s83, s83, 4096
    buffer_load_dwordx4 v2, s[20:23], s84 offen sc1 lds
    s_add_u32 s84, s84, 4096
    s_add_u32 m0, s82, 57344
    s_nop 0
    buffer_load_dwordx4 v2, s[20:23], s83 offen sc1 lds
    s_add_u32 m0, s82, 139264
    s_add_u32 s83, s83, 4096
    buffer_load_dwordx4 v2, s[20:23], s84 offen sc1 lds
    s_add_u32 s84, s84, 4096
    s_add_u32 m0, s82, 61440
    s_nop 0
    buffer_load_dwordx4 v2, s[20:23], s83 offen sc1 lds
    s_add_u32 m0, s82, 143360
    s_add_u32 s83, s83, 4096
    buffer_load_dwordx4 v2, s[20:23], s84 offen sc1 lds
    s_add_u32 s84, s84, 4096
    s_add_u32 m0, s82, 65536
    s_nop 0
    buffer_load_dwordx4 v2, s[20:23], s83 offen sc1 lds
    s_add_u32 m0, s82, 147456
    s_add_u32 s83, s83, 4096
    buffer_load_dwordx4 v2, s[20:23], s84 offen sc1 lds
    s_add_u32 s84, s84, 4096
    s_add_u32 m0, s82, 69632
    s_nop 0
    buffer_load_dwordx4 v2, s[20:23], s83 offen sc1 lds
    s_add_u32 m0, s82, 151552
    s_add_u32 s83, s83, 4096
    buffer_load_dwordx4 v2, s[20:23], s84 offen sc1 lds
    s_add_u32 s84, s84, 4096
    s_add_u32 m0, s82, 73728
    s_nop 0
    buffer_load_dwordx4 v2, s[20:23], s83 offen sc1 lds
    s_add_u32 m0, s82, 155648
    s_add_u32 s83, s83, 4096
    buffer_load_dwordx4 v2, s[20:23], s84 offen sc1 lds
    s_add_u32 s84, s84, 4096
    s_add_u32 m0, s82, 77824
    s_nop 0
    buffer_load_dwordx4 v2, s[20:23], s83 offen sc1 lds
    s_add_u32 m0, s82, 159744
    s_add_u32 s83, s83, 4096
    buffer_load_dwordx4 v2, s[20:23], s84 offen sc1 lds
    s_add_u32 s84, s84, 4096
    s_mul_i32 s82, s67, 27
    s_mul_i32 s74, s65, 108
    s_add_u32 s74, s74, s82
    s_lshl_b32 s74, s74, 10
    s_add_u32 s74, s74, 0
    s_mul_i32 s75, s66, 740
    s_add_u32 s82, s82, s75
    s_lshl_b32 s82, s82, 10
    s_add_u32 s76, s82, 11534336
    s_add_u32 s77, s76, 151552
    s_add_u32 s78, s77, 151552
    s_add_u32 s79, s78, 151552
    s_add_u32 s80, s79, 151552
    v_mov_b32 v44, 0
    v_mov_b32 v45, 0
    v_mov_b32 v46, 0
    v_mov_b32 v47, 0
    v_mov_b32 v48, 0
    v_mov_b32 v49, 0
    v_mov_b32 v50, 0
    v_mov_b32 v51, 0
    v_mov_b32 v52, 0
    v_mov_b32 v53, 0
    v_mov_b32 v54, 0
    v_mov_b32 v55, 0
    v_mov_b32 v56, 0
    v_mov_b32 v57, 0
    v_mov_b32 v58, 0
    v_mov_b32 v59, 0
    s_waitcnt vmcnt(0)
    ds_write_b32 v102, v101
    s_cmp_lg_u32 s64, 1
    s_cbranch_scc1 k2_gowait
    v_lshlrev_b32 v3, 8, v1
    s_mov_b32 s85, 14893056
    s_mov_b32 s86, 0x40000
x_L41:
    buffer_load_dwordx4 v[84:87], v3, s[20:23], s85 offen offset:0 sc1
    buffer_load_dwordx4 v[88:91], v3, s[20:23], s85 offen offset:64 sc1
    buffer_load_dwordx4 v[92:95], v3, s[20:23], s85 offen offset:128 sc1
    buffer_load_dwordx4 v[96:99], v3, s[20:23], s85 offen offset:192 sc1
    s_waitcnt vmcnt(0)
    v_and_b32 v84, v84, v85
    v_and_b32 v84, v84, v86
    v_and_b32 v84, v84, v87
    v_and_b32 v84, v84, v88
    v_and_b32 v84, v84, v89
    v_and_b32 v84, v84, v90
    v_and_b32 v84, v84, v91
    v_and_b32 v84, v84, v92
    v_and_b32 v84, v84, v93
    v_and_b32 v84, v84, v94
    v_and_b32 v84, v84, v95
    v_and_b32 v84, v84, v96
    v_and_b32 v84, v84, v97
    v_and_b32 v84, v84, v98
    v_and_b32 v84, v84, v99
    v_and_b32 v84, 1, v84
    v_cmp_ne_u32 vcc, 1, v84
    s_sub_u32 s86, s86, 1
    s_cbranch_vccz x_L41x
    s_sleep 16
    s_cbranch_scc0 x_L41
x_L41x:
    ds_write_b32 v100, v101 offset:16
    s_andn2_b32 s86, s2, 24
    s_lshl_b32 s86, s86, 6
    s_add_u32 s86, s86, 14893056
    v_and_b32 v3, 3, v1
    v_lshlrev_b32 v3, 9, v3
    buffer_load_dword v84, v3, s[20:23], s86 offen sc1
    s_waitcnt vmcnt(0)
    v_cmp_ne_u32 vcc, v84, v103
    s_nop 1
    s_cbranch_vccnz k2_gowait
    ds_write_b32 v100, v101 offset:96
k2_gowait:
x_L42:
    ds_read_b32 v84, v100 offset:16
    s_waitcnt lgkmcnt(0)
    v_cmp_ne_u32 vcc, 1, v84
    s_nop 0
    s_cbranch_vccz x_L42x
    s_sleep 4
    s_branch x_L42
x_L42x:
k2_go:
    s_lshr_b32 s81, s67, 1
    s_mul_i32 s81, s81, 81920
    s_and_b32 s82, s67, 1
    s_mul_i32 s83, s82, 10240
    s_add_u32 s73, s81, s83
    s_add_u32 s73, s73, 61440
    s_mul_i32 s82, s82, 30720
    s_add_u32 s81, s81, s82
    s_mul_i32 s82, s67, 10
    s_add_u32 s92, s82, s75
    s_add_u32 s92, s92, 256
    s_lshl_b32 s92, s92, 10
    s_add_u32 s92, s92, 11534336
    s_mov_b32 s95, 0
    s_cmp_eq_u32 s67, 0
    s_cselect_b32 s82, 4, 8
    v_min_u32 v164, 15, v1
    v_max_u32 v164, s82, v164
    v_lshlrev_b32 v164, 2, v164
    v_mov_b32 v165, v102
    s_setprio 0
    buffer_load_dwordx4 v[84:87], v2, s[20:23], s74 offen offset:0 sc1
    buffer_load_dwordx4 v[88:91], v2, s[20:23], s76 offen offset:0 sc1
    buffer_load_dwordx4 v[92:95], v2, s[20:23], s77 offen offset:0 sc1
    buffer_load_dwordx4 v[96:99], v2, s[20:23], s78 offen offset:0 sc1
    buffer_load_dwordx4 v[100:103], v2, s[20:23], s79 offen offset:0 sc1
    buffer_load_dwordx4 v[104:107], v2, s[20:23], s80 offen offset:0 sc1
    buffer_load_dwordx4 v[108:111], v2, s[20:23], s74 offen offset:1024 sc1
    buffer_load_dwordx4 v[112:115], v2, s[20:23], s76 offen offset:1024 sc1
    buffer_load_dwordx4 v[116:119], v2, s[20:23], s77 offen offset:1024 sc1
    buffer_load_dwordx4 v[120:123], v2, s[20:23], s78 offen offset:1024 sc1
    buffer_load_dwordx4 v[124:127], v2, s[20:23], s79 offen offset:1024 sc1
    buffer_load_dwordx4 v[128:131], v2, s[20:23], s80 offen offset:1024 sc1
    buffer_load_dwordx4 v[132:135], v2, s[20:23], s74 offen offset:2048 sc1
    buffer_load_dwordx4 v[136:139], v2, s[20:23], s76 offen offset:2048 sc1
    buffer_load_dwordx4 v[140:143], v2, s[20:23], s77 offen offset:2048 sc1
    buffer_load_dwordx4 v[144:147], v2, s[20:23], s78 offen offset:2048 sc1
    buffer_load_dwordx4 v[148:151], v2, s[20:23], s79 offen offset:2048 sc1
    buffer_load_dwordx4 v[152:155], v2, s[20:23], s80 offen offset:2048 sc1
    s_add_u32 s74, s74, 3072
    s_add_u32 s76, s76, 3072
    s_add_u32 s77, s77, 3072
    s_add_u32 s78, s78, 3072
    s_add_u32 s79, s79, 3072
    s_add_u32 s80, s80, 3072
    s_mov_b32 s69, 0
k2_gtop:
    s_waitcnt vmcnt(12)
    v_mfma_f32_32x32x16_bf16 v[4:19], v[88:91], v[84:87], v[4:19]
    v_mfma_f32_32x32x16_bf16 v[20:35], v[92:95], v[84:87], v[20:35]
    v_mfma_f32_32x32x16_bf16 v[36:51], v[96:99], v[84:87], v[36:51]
    v_mfma_f32_32x32x16_bf16 v[52:67], v[100:103], v[84:87], v[52:67]
    v_mfma_f32_32x32x16_bf16 v[68:83], v[104:107], v[84:87], v[68:83]
    buffer_load_dwordx4 v[84:87], v2, s[20:23], s74 offen offset:0 sc1
    buffer_load_dwordx4 v[88:91], v2, s[20:23], s76 offen offset:0 sc1
    buffer_load_dwordx4 v[92:95], v2, s[20:23], s77 offen offset:0 sc1
    buffer_load_dwordx4 v[96:99], v2, s[20:23], s78 offen offset:0 sc1
    buffer_load_dwordx4 v[100:103], v2, s[20:23], s79 offen offset:0 sc1
    buffer_load_dwordx4 v[104:107], v2, s[20:23], s80 offen offset:0 sc1
    s_waitcnt vmcnt(12)
    v_mfma_f32_32x32x16_bf16 v[4:19], v[112:115], v[108:111], v[4:19]
    v_mfma_f32_32x32x16_bf16 v[20:35], v[116:119], v[108:111], v[20:35]
    v_mfma_f32_32x32x16_bf16 v[36:51], v[120:123], v[108:111], v[36:51]
    v_mfma_f32_32x32x16_bf16 v[52:67], v[124:127], v[108:111], v[52:67]
    v_mfma_f32_32x32x16_bf16 v[68:83], v[128:131], v[108:111], v[68:83]
    buffer_load_dwordx4 v[108:111], v2, s[20:23], s74 offen offset:1024 sc1
    buffer_load_dwordx4 v[112:115], v2, s[20:23], s76 offen offset:1024 sc1
    buffer_load_dwordx4 v[116:119], v2, s[20:23], s77 offen offset:1024 sc1
    buffer_load_dwordx4 v[120:123], v2, s[20:23], s78 offen offset:1024 sc1
    buffer_load_dwordx4 v[124:127], v2, s[20:23], s79 offen offset:1024 sc1
    buffer_load_dwordx4 v[128:131], v2, s[20:23], s80 offen offset:1024 sc1
    s_waitcnt vmcnt(12)
    v_mfma_f32_32x32x16_bf16 v[4:19], v[136:139], v[132:135], v[4:19]
    v_mfma_f32_32x32x16_bf16 v[20:35], v[140:143], v[132:135], v[20:35]
    v_mfma_f32_32x32x16_bf16 v[36:51], v[144:147], v[132:135], v[36:51]
    v_mfma_f32_32x32x16_bf16 v[52:67], v[148:151], v[132:135], v[52:67]
    v_mfma_f32_32x32x16_bf16 v[68:83], v[152:155], v[132:135], v[68:83]
    buffer_load_dwordx4 v[132:135], v2, s[20:23], s74 offen offset:2048 sc1
    buffer_load_dwordx4 v[136:139], v2, s[20:23], s76 offen offset:2048 sc1
    buffer_load_dwordx4 v[140:143], v2, s[20:23], s77 offen offset:2048 sc1
    buffer_load_dwordx4 v[144:147], v2, s[20:23], s78 offen offset:2048 sc1
    buffer_load_dwordx4 v[148:151], v2, s[20:23], s79 offen offset:2048 sc1
    buffer_load_dwordx4 v[152:155], v2, s[20:23], s80 offen offset:2048 sc1
    s_add_u32 s74, s74, 3072
    s_add_u32 s76, s76, 3072
    s_add_u32 s77, s77, 3072
    s_add_u32 s78, s78, 3072
    s_add_u32 s79, s79, 3072
    s_add_u32 s80, s80, 3072
    s_cmp_lg_u32 s95, 0
    s_cbranch_scc1 k2_gnext
    ds_read_b32 v166, v164
    s_setprio 3
    s_waitcnt lgkmcnt(0)
    v_cmp_ne_u32 vcc, 1, v166
    s_nop 0
    s_cbranch_vccz k2_gw
    s_setprio 0
k2_gnext:
    s_add_u32 s69, s69, 1
    s_cmp_lt_u32 s69, 8
    s_cbranch_scc1 k2_gtop
    s_mul_i32 s82, s67, 10
    s_add_u32 s83, s82, s75
    s_add_u32 s83, s83, 108
    s_lshl_b32 s83, s83, 10
    s_add_u32 s76, s83, 11534336
    s_mul_i32 s74, s65, 40
    s_add_u32 s74, s74, s82
    s_lshl_b32 s74, s74, 10
    s_add_u32 s74, s74, 15728640
    s_add_u32 s77, s76, 151552
    s_add_u32 s78, s77, 151552
    s_add_u32 s79, s78, 151552
    s_add_u32 s80, s79, 151552
    s_waitcnt vmcnt(12)
    v_mfma_f32_32x32x16_bf16 v[4:19], v[88:91], v[84:87], v[4:19]
    v_mfma_f32_32x32x16_bf16 v[20:35], v[92:95], v[84:87], v[20:35]
    v_mfma_f32_32x32x16_bf16 v[36:51], v[96:99], v[84:87], v[36:51]
    v_mfma_f32_32x32x16_bf16 v[52:67], v[100:103], v[84:87], v[52:67]
    v_mfma_f32_32x32x16_bf16 v[68:83], v[104:107], v[84:87], v[68:83]
    s_waitcnt vmcnt(6)
    v_mfma_f32_32x32x16_bf16 v[4:19], v[112:115], v[108:111], v[4:19]
    v_mfma_f32_32x32x16_bf16 v[20:35], v[116:119], v[108:111], v[20:35]
    v_mfma_f32_32x32x16_bf16 v[36:51], v[120:123], v[108:111], v[36:51]
    v_mfma_f32_32x32x16_bf16 v[52:67], v[124:127], v[108:111], v[52:67]
    v_mfma_f32_32x32x16_bf16 v[68:83], v[128:131], v[108:111], v[68:83]
    s_waitcnt vmcnt(0)
    v_mfma_f32_32x32x16_bf16 v[4:19], v[136:139], v[132:135], v[4:19]
    v_mfma_f32_32x32x16_bf16 v[20:35], v[140:143], v[132:135], v[20:35]
    v_mfma_f32_32x32x16_bf16 v[36:51], v[144:147], v[132:135], v[36:51]
    v_mfma_f32_32x32x16_bf16 v[52:67], v[148:151], v[132:135], v[52:67]
    v_mfma_f32_32x32x16_bf16 v[68:83], v[152:155], v[132:135], v[68:83]
    s_setprio 3
    s_add_u32 s82, s76, 4096
    s_add_u32 s83, s76, 8192
    buffer_load_dwordx4 v[84:87], v2, s[20:23], s76 offen offset:0 sc1
    buffer_load_dwordx4 v[88:91], v2, s[20:23], s76 offen offset:1024 sc1
    buffer_load_dwordx4 v[92:95], v2, s[20:23], s76 offen offset:2048 sc1
    buffer_load_dwordx4 v[96:99], v2, s[20:23], s76 offen offset:3072 sc1
    buffer_load_dwordx4 v[100:103], v2, s[20:23], s82 offen offset:0 sc1
    buffer_load_dwordx4 v[104:107], v2, s[20:23], s82 offen offset:1024 sc1
    buffer_load_dwordx4 v[108:111], v2, s[20:23], s82 offen offset:2048 sc1
    buffer_load_dwordx4 v[112:115], v2, s[20:23], s82 offen offset:3072 sc1
    buffer_load_dwordx4 v[116:119], v2, s[20:23], s83 offen offset:0 sc1
    buffer_load_dwordx4 v[120:123], v2, s[20:23], s83 offen offset:1024 sc1
    v_lshlrev_b32 v3, 7, v1
    buffer_load_dword v124, v3, s[20:23], s80 offen sc1
    v_add_u32 v3, 2048, v3
    buffer_load_dword v125, v3, s[20:23], s80 offen sc1
    s_cmp_lg_u32 s95, 0
    s_cbranch_scc1 k2_wdone
x_L43:
    ds_read_b32 v166, v164
    s_waitcnt lgkmcnt(0)
    v_cmp_ne_u32 vcc, 1, v166
    s_nop 0
    s_cbranch_vccz x_L43x
    s_sleep 4
    s_branch x_L43
x_L43x:
    ds_write_b32 v165, v166 offset:16
    s_waitcnt lgkmcnt(0)
    s_add_u32 m0, s81, 0
    s_add_u32 s93, s92, 0
    buffer_load_dwordx4 v2, s[20:23], s93 offen offset:0 sc1 lds
    buffer_load_dwordx4 v2, s[20:23], s93 offen offset:1024 sc1 lds
    buffer_load_dwordx4 v2, s[20:23], s93 offen offset:2048 sc1 lds
    buffer_load_dwordx4 v2, s[20:23], s93 offen offset:3072 sc1 lds
    s_add_u32 m0, s81, 4096
    s_add_u32 s93, s92, 4096
    buffer_load_dwordx4 v2, s[20:23], s93 offen offset:0 sc1 lds
    buffer_load_dwordx4 v2, s[20:23], s93 offen offset:1024 sc1 lds
    buffer_load_dwordx4 v2, s[20:23], s93 offen offset:2048 sc1 lds
    buffer_load_dwordx4 v2, s[20:23], s93 offen offset:3072 sc1 lds
    s_add_u32 m0, s81, 8192
    s_add_u32 s93, s92, 8192
    buffer_load_dwordx4 v2, s[20:23], s93 offen offset:0 sc1 lds
    buffer_load_dwordx4 v2, s[20:23], s93 offen offset:1024 sc1 lds
    s_add_u32 m0, s81, 10240
    s_add_u32 s93, s92, 151552
    buffer_load_dwordx4 v2, s[20:23], s93 offen offset:0 sc1 lds
    buffer_load_dwordx4 v2, s[20:23], s93 offen offset:1024 sc1 lds
    buffer_load_dwordx4 v2, s[20:23], s93 offen offset:2048 sc1 lds
    buffer_load_dwordx4 v2, s[20:23], s93 offen offset:3072 sc1 lds
    s_add_u32 m0, s81, 14336
    s_add_u32 s93, s92, 155648
    buffer_load_dwordx4 v2, s[20:23], s93 offen offset:0 sc1 lds
    buffer_load_dwordx4 v2, s[20:23], s93 offen offset:1024 sc1 lds
    buffer_load_dwordx4 v2, s[20:23], s93 offen offset:2048 sc1 lds
    buffer_load_dwordx4 v2, s[20:23], s93 offen offset:3072 sc1 lds
    s_add_u32 m0, s81, 18432
    s_add_u32 s93, s92, 159744
    buffer_load_dwordx4 v2, s[20:23], s93 offen offset:0 sc1 lds
    buffer_load_dwordx4 v2, s[20:23], s93 offen offset:1024 sc1 lds
    s_add_u32 m0, s81, 20480
    s_add_u32 s93, s92, 303104
    buffer_load_dwordx4 v2, s[20:23], s93 offen offset:0 sc1 lds
    buffer_load_dwordx4 v2, s[20:23], s93 offen offset:1024 sc1 lds
    buffer_load_dwordx4 v2, s[20:23], s93 offen offset:2048 sc1 lds
    buffer_load_dwordx4 v2, s[20:23], s93 offen offset:3072 sc1 lds
    s_add_u32 m0, s81, 24576
    s_add_u32 s93, s92, 307200
    buffer_load_dwordx4 v2, s[20:23], s93 offen offset:0 sc1 lds
    buffer_load_dwordx4 v2, s[20:23], s93 offen offset:1024 sc1 lds
    buffer_load_dwordx4 v2, s[20:23], s93 offen offset:2048 sc1 lds
    buffer_load_dwordx4 v2, s[20:23], s93 offen offset:3072 sc1 lds
    s_add_u32 m0, s81, 28672
    s_add_u32 s93, s92, 311296
    buffer_load_dwordx4 v2, s[20:23], s93 offen offset:0 sc1 lds
    buffer_load_dwordx4 v2, s[20:23], s93 offen offset:1024 sc1 lds
k2_wdone:
    s_add_u32 s82, s74, 4096
    s_add_u32 s83, s74, 8192
    v_add_u32 v3, s81, v2
    v_add_u32 v0, s73, v2
    v_and_b32 v165, 31, v1
    v_lshrrev_b32 v164, 5, v1
    v_mul_u32_u24 v165, 144, v165
    v_lshl_add_u32 v165, v164, 4, v165
    v_add_u32 v165, s81, v165
    s_mov_b32 s84, 0x40000
    s_waitcnt vmcnt(0)
    s_barrier
    s_barrier
    s_barrier
    buffer_load_dwordx4 v[124:127], v2, s[20:23], s74 offen offset:0 sc1
    buffer_load_dwordx4 v[128:131], v2, s[20:23], s74 offen offset:1024 sc1
    buffer_load_dwordx4 v[132:135], v2, s[20:23], s74 offen offset:2048 sc1
    buffer_load_dwordx4 v[136:139], v2, s[20:23], s74 offen offset:3072 sc1
    buffer_load_dwordx4 v[140:143], v2, s[20:23], s82 offen offset:0 sc1
    buffer_load_dwordx4 v[144:147], v2, s[20:23], s82 offen offset:1024 sc1
    buffer_load_dwordx4 v[148:151], v2, s[20:23], s82 offen offset:2048 sc1
    buffer_load_dwordx4 v[152:155], v2, s[20:23], s82 offen offset:3072 sc1
    buffer_load_dwordx4 v[156:159], v2, s[20:23], s83 offen offset:0 sc1
    buffer_load_dwordx4 v[160:163], v2, s[20:23], s83 offen offset:1024 sc1
k2_oc0:
    s_waitcnt vmcnt(9)
    v_max3_u32 v164, v124, v125, v126
    v_max_u32 v164, v164, v127
    v_cmp_eq_u32 vcc, -1, v164
    s_nop 0
    s_cbranch_vccnz k2_or0
k2_og0:
    v_mfma_f32_32x32x16_bf16 v[4:19], v[84:87], v[124:127], v[4:19]
    ds_read_b128 v[84:87], v3 offset:0
k2_oc1:
    s_waitcnt vmcnt(8)
    v_max3_u32 v164, v128, v129, v130
    v_max_u32 v164, v164, v131
    v_cmp_eq_u32 vcc, -1, v164
    s_nop 0
    s_cbranch_vccnz k2_or1
k2_og1:
    v_mfma_f32_32x32x16_bf16 v[4:19], v[88:91], v[128:131], v[4:19]
    ds_read_b128 v[88:91], v3 offset:1024
k2_oc2:
    s_waitcnt vmcnt(7)
    v_max3_u32 v164, v132, v133, v134
    v_max_u32 v164, v164, v135
    v_cmp_eq_u32 vcc, -1, v164
    s_nop 0
    s_cbranch_vccnz k2_or2
k2_og2:
    v_mfma_f32_32x32x16_bf16 v[4:19], v[92:95], v[132:135], v[4:19]
    ds_read_b128 v[92:95], v3 offset:2048
k2_oc3:
    s_waitcnt vmcnt(6)
    v_max3_u32 v164, v136, v137, v138
    v_max_u32 v164, v164, v139
    v_cmp_eq_u32 vcc, -1, v164
    s_nop 0
    s_cbranch_vccnz k2_or3
k2_og3:
    v_mfma_f32_32x32x16_bf16 v[4:19], v[96:99], v[136:139], v[4:19]
    ds_read_b128 v[96:99], v3 offset:3072
k2_oc4:
    s_waitcnt vmcnt(5)
    v_max3_u32 v164, v140, v141, v142
    v_max_u32 v164, v164, v143
    v_cmp_eq_u32 vcc, -1, v164
    s_nop 0
    s_cbranch_vccnz k2_or4
k2_og4:
    v_mfma_f32_32x32x16_bf16 v[4:19], v[100:103], v[140:143], v[4:19]
    ds_read_b128 v[100:103], v3 offset:4096
k2_oc5:
    s_waitcnt vmcnt(4)
    v_max3_u32 v164, v144, v145, v146
    v_max_u32 v164, v164, v147
    v_cmp_eq_u32 vcc, -1, v164
    s_nop 0
    s_cbranch_vccnz k2_or5
k2_og5:
    v_mfma_f32_32x32x16_bf16 v[4:19], v[104:107], v[144:147], v[4:19]
    ds_read_b128 v[104:107], v3 offset:5120
k2_oc6:
    s_waitcnt vmcnt(3)
    v_max3_u32 v164, v148, v149, v150
    v_max_u32 v164, v164, v151
    v_cmp_eq_u32 vcc, -1, v164
    s_nop 0
    s_cbranch_vccnz k2_or6
k2_og6:
    v_mfma_f32_32x32x16_bf16 v[4:19], v[108:111], v[148:151], v[4:19]
    ds_read_b128 v[108:111], v3 offset:6144
k2_oc7:
    s_waitcnt vmcnt(2)
    v_max3_u32 v164, v152, v153, v154
    v_max_u32 v164, v164, v155
    v_cmp_eq_u32 vcc, -1, v164
    s_nop 0
    s_cbranch_vccnz k2_or7
k2_og7:
    v_mfma_f32_32x32x16_bf16 v[4:19], v[112:115], v[152:155], v[4:19]
    ds_read_b128 v[112:115], v3 offset:7168
k2_oc8:
    s_waitcnt vmcnt(1)
    v_max3_u32 v164, v156, v157, v158
    v_max_u32 v164, v164, v159
    v_cmp_eq_u32 vcc, -1, v164
    s_nop 0
    s_cbranch_vccnz k2_or8
k2_og8:
    v_mfma_f32_32x32x16_bf16 v[4:19], v[116:119], v[156:159], v[4:19]
    ds_read_b128 v[116:119], v3 offset:8192
k2_oc9:
    s_waitcnt vmcnt(0)
    v_max3_u32 v164, v160, v161, v162
    v_max_u32 v164, v164, v163
    v_cmp_eq_u32 vcc, -1, v164
    s_nop 0
    s_cbranch_vccnz k2_or9
k2_og9:
    v_mfma_f32_32x32x16_bf16 v[4:19], v[120:123], v[160:163], v[4:19]
    ds_read_b128 v[120:123], v3 offset:9216
    s_waitcnt lgkmcnt(9)
    v_mfma_f32_32x32x16_bf16 v[20:35], v[84:87], v[124:127], v[20:35]
    ds_read_b128 v[84:87], v3 offset:10240
    s_add_u32 m0, s73, 0
    s_add_u32 s85, s80, 0
    buffer_load_dwordx4 v2, s[20:23], s85 offen offset:0 sc1 lds
    s_waitcnt lgkmcnt(9)
    v_mfma_f32_32x32x16_bf16 v[20:35], v[88:91], v[128:131], v[20:35]
    ds_read_b128 v[88:91], v3 offset:11264
    buffer_load_dwordx4 v2, s[20:23], s85 offen offset:1024 sc1 lds
    s_waitcnt lgkmcnt(9)
    v_mfma_f32_32x32x16_bf16 v[20:35], v[92:95], v[132:135], v[20:35]
    ds_read_b128 v[92:95], v3 offset:12288
    buffer_load_dwordx4 v2, s[20:23], s85 offen offset:2048 sc1 lds
    s_waitcnt lgkmcnt(9)
    v_mfma_f32_32x32x16_bf16 v[20:35], v[96:99], v[136:139], v[20:35]
    ds_read_b128 v[96:99], v3 offset:13312
    buffer_load_dwordx4 v2, s[20:23], s85 offen offset:3072 sc1 lds
    s_waitcnt lgkmcnt(9)
    v_mfma_f32_32x32x16_bf16 v[20:35], v[100:103], v[140:143], v[20:35]
    ds_read_b128 v[100:103], v3 offset:14336
    s_add_u32 m0, s73, 4096
    s_add_u32 s85, s80, 4096
    buffer_load_dwordx4 v2, s[20:23], s85 offen offset:0 sc1 lds
    s_waitcnt lgkmcnt(9)
    v_mfma_f32_32x32x16_bf16 v[20:35], v[104:107], v[144:147], v[20:35]
    ds_read_b128 v[104:107], v3 offset:15360
    buffer_load_dwordx4 v2, s[20:23], s85 offen offset:1024 sc1 lds
    ds_write_b128 v165, v[4:7] offset:0
    s_waitcnt lgkmcnt(10)
    v_mfma_f32_32x32x16_bf16 v[20:35], v[108:111], v[148:151], v[20:35]
    ds_read_b128 v[108:111], v3 offset:16384
    buffer_load_dwordx4 v2, s[20:23], s85 offen offset:2048 sc1 lds
    ds_write_b128 v165, v[8:11] offset:32
    s_waitcnt lgkmcnt(11)
    v_mfma_f32_32x32x16_bf16 v[20:35], v[112:115], v[152:155], v[20:35]
    ds_read_b128 v[112:115], v3 offset:17408
    buffer_load_dwordx4 v2, s[20:23], s85 offen offset:3072 sc1 lds
    ds_write_b128 v165, v[12:15] offset:64
    s_waitcnt lgkmcnt(12)
    v_mfma_f32_32x32x16_bf16 v[20:35], v[116:119], v[156:159], v[20:35]
    ds_read_b128 v[116:119], v3 offset:18432
    s_add_u32 m0, s73, 8192
    s_add_u32 s85, s80, 8192
    buffer_load_dwordx4 v2, s[20:23], s85 offen offset:0 sc1 lds
    ds_write_b128 v165, v[16:19] offset:96
    s_waitcnt lgkmcnt(13)
    v_mfma_f32_32x32x16_bf16 v[20:35], v[120:123], v[160:163], v[20:35]
    ds_read_b128 v[120:123], v3 offset:19456
    buffer_load_dwordx4 v2, s[20:23], s85 offen offset:1024 sc1 lds
    s_waitcnt lgkmcnt(13)
    v_mfma_f32_32x32x16_bf16 v[36:51], v[84:87], v[124:127], v[36:51]
    ds_read_b128 v[84:87], v3 offset:20480
    s_waitcnt lgkmcnt(13)
    v_mfma_f32_32x32x16_bf16 v[36:51], v[88:91], v[128:131], v[36:51]
    ds_read_b128 v[88:91], v3 offset:21504
    s_waitcnt lgkmcnt(13)
    v_mfma_f32_32x32x16_bf16 v[36:51], v[92:95], v[132:135], v[36:51]
    ds_read_b128 v[92:95], v3 offset:22528
    s_waitcnt lgkmcnt(13)
    v_mfma_f32_32x32x16_bf16 v[36:51], v[96:99], v[136:139], v[36:51]
    ds_read_b128 v[96:99], v3 offset:23552
    s_waitcnt lgkmcnt(13)
    v_mfma_f32_32x32x16_bf16 v[36:51], v[100:103], v[140:143], v[36:51]
    ds_read_b128 v[100:103], v3 offset:24576
    s_waitcnt lgkmcnt(13)
    v_mfma_f32_32x32x16_bf16 v[36:51], v[104:107], v[144:147], v[36:51]
    ds_read_b128 v[104:107], v3 offset:25600
    ds_write_b128 v165, v[20:23] offset:4624
    s_waitcnt lgkmcnt(13)
    v_mfma_f32_32x32x16_bf16 v[36:51], v[108:111], v[148:151], v[36:51]
    ds_read_b128 v[108:111], v3 offset:26624
    ds_write_b128 v165, v[24:27] offset:4656
    s_waitcnt lgkmcnt(13)
    v_mfma_f32_32x32x16_bf16 v[36:51], v[112:115], v[152:155], v[36:51]
    ds_read_b128 v[112:115], v3 offset:27648
    ds_write_b128 v165, v[28:31] offset:4688
    s_waitcnt lgkmcnt(13)
    v_mfma_f32_32x32x16_bf16 v[36:51], v[116:119], v[156:159], v[36:51]
    ds_read_b128 v[116:119], v3 offset:28672
    ds_write_b128 v165, v[32:35] offset:4720
    s_waitcnt lgkmcnt(13)
    v_mfma_f32_32x32x16_bf16 v[36:51], v[120:123], v[160:163], v[36:51]
    ds_read_b128 v[120:123], v3 offset:29696
    s_waitcnt vmcnt(0)
    s_waitcnt lgkmcnt(13)
    v_mfma_f32_32x32x16_bf16 v[52:67], v[84:87], v[124:127], v[52:67]
    ds_read_b128 v[84:87], v0 offset:0
    s_waitcnt lgkmcnt(13)
    v_mfma_f32_32x32x16_bf16 v[52:67], v[88:91], v[128:131], v[52:67]
    ds_read_b128 v[88:91], v0 offset:1024
    s_waitcnt lgkmcnt(13)
    v_mfma_f32_32x32x16_bf16 v[52:67], v[92:95], v[132:135], v[52:67]
    ds_read_b128 v[92:95], v0 offset:2048
    s_waitcnt lgkmcnt(13)
    v_mfma_f32_32x32x16_bf16 v[52:67], v[96:99], v[136:139], v[52:67]
    ds_read_b128 v[96:99], v0 offset:3072
    s_waitcnt lgkmcnt(13)
    v_mfma_f32_32x32x16_bf16 v[52:67], v[100:103], v[140:143], v[52:67]
    ds_read_b128 v[100:103], v0 offset:4096
    s_waitcnt lgkmcnt(13)
    v_mfma_f32_32x32x16_bf16 v[52:67], v[104:107], v[144:147], v[52:67]
    ds_read_b128 v[104:107], v0 offset:5120
    ds_write_b128 v165, v[36:39] offset:9248
    s_waitcnt lgkmcnt(13)
    v_mfma_f32_32x32x16_bf16 v[52:67], v[108:111], v[148:151], v[52:67]
    ds_read_b128 v[108:111], v0 offset:6144
    ds_write_b128 v165, v[40:43] offset:9280
    s_waitcnt lgkmcnt(13)
    v_mfma_f32_32x32x16_bf16 v[52:67], v[112:115], v[152:155], v[52:67]
    ds_read_b128 v[112:115], v0 offset:7168
    ds_write_b128 v165, v[44:47] offset:9312
    s_waitcnt lgkmcnt(13)
    v_mfma_f32_32x32x16_bf16 v[52:67], v[116:119], v[156:159], v[52:67]
    ds_read_b128 v[116:119], v0 offset:8192
    ds_write_b128 v165, v[48:51] offset:9344
    s_waitcnt lgkmcnt(13)
    v_mfma_f32_32x32x16_bf16 v[52:67], v[120:123], v[160:163], v[52:67]
    ds_read_b128 v[120:123], v0 offset:9216
    s_waitcnt lgkmcnt(13)
    v_mfma_f32_32x32x16_bf16 v[68:83], v[84:87], v[124:127], v[68:83]
    s_waitcnt lgkmcnt(12)
    v_mfma_f32_32x32x16_bf16 v[68:83], v[88:91], v[128:131], v[68:83]
    s_waitcnt lgkmcnt(11)
    v_mfma_f32_32x32x16_bf16 v[68:83], v[92:95], v[132:135], v[68:83]
    s_waitcnt lgkmcnt(10)
    v_mfma_f32_32x32x16_bf16 v[68:83], v[96:99], v[136:139], v[68:83]
    s_waitcnt lgkmcnt(9)
    v_mfma_f32_32x32x16_bf16 v[68:83], v[100:103], v[140:143], v[68:83]
    s_waitcnt lgkmcnt(8)
    v_mfma_f32_32x32x16_bf16 v[68:83], v[104:107], v[144:147], v[68:83]
    ds_write_b128 v165, v[52:55] offset:13872
    s_waitcnt lgkmcnt(7)
    v_mfma_f32_32x32x16_bf16 v[68:83], v[108:111], v[148:151], v[68:83]
    ds_write_b128 v165, v[56:59] offset:13904
    s_waitcnt lgkmcnt(6)
    v_mfma_f32_32x32x16_bf16 v[68:83], v[112:115], v[152:155], v[68:83]
    ds_write_b128 v165, v[60:63] offset:13936
    s_waitcnt lgkmcnt(5)
    v_mfma_f32_32x32x16_bf16 v[68:83], v[116:119], v[156:159], v[68:83]
    ds_write_b128 v165, v[64:67] offset:13968
    s_waitcnt lgkmcnt(4)
    v_mfma_f32_32x32x16_bf16 v[68:83], v[120:123], v[160:163], v[68:83]
    s_nop 11
    ds_write_b128 v165, v[68:71] offset:18496
    ds_write_b128 v165, v[72:75] offset:18528
    ds_write_b128 v165, v[76:79] offset:18560
    ds_write_b128 v165, v[80:83] offset:18592
    s_waitcnt lgkmcnt(0)
    s_barrier
    s_endpgm
k2_or0:
    s_cmp_eq_u32 s84, 0
    s_cbranch_scc1 k2_og0
    s_sub_u32 s84, s84, 1
    s_sleep 2
    buffer_load_dwordx4 v[124:127], v2, s[20:23], s74 offen offset:0 sc1
    buffer_load_dwordx4 v[128:131], v2, s[20:23], s74 offen offset:1024 sc1
    buffer_load_dwordx4 v[132:135], v2, s[20:23], s74 offen offset:2048 sc1
    buffer_load_dwordx4 v[136:139], v2, s[20:23], s74 offen offset:3072 sc1
    buffer_load_dwordx4 v[140:143], v2, s[20:23], s82 offen offset:0 sc1
    buffer_load_dwordx4 v[144:147], v2, s[20:23], s82 offen offset:1024 sc1
    buffer_load_dwordx4 v[148:151], v2, s[20:23], s82 offen offset:2048 sc1
    buffer_load_dwordx4 v[152:155], v2, s[20:23], s82 offen offset:3072 sc1
    buffer_load_dwordx4 v[156:159], v2, s[20:23], s83 offen offset:0 sc1
    buffer_load_dwordx4 v[160:163], v2, s[20:23], s83 offen offset:1024 sc1
    s_waitcnt vmcnt(0)
    s_branch k2_oc0
k2_or1:
    s_cmp_eq_u32 s84, 0
    s_cbranch_scc1 k2_og1
    s_sub_u32 s84, s84, 1
    s_sleep 2
    buffer_load_dwordx4 v[128:131], v2, s[20:23], s74 offen offset:1024 sc1
    buffer_load_dwordx4 v[132:135], v2, s[20:23], s74 offen offset:2048 sc1
    buffer_load_dwordx4 v[136:139], v2, s[20:23], s74 offen offset:3072 sc1
    buffer_load_dwordx4 v[140:143], v2, s[20:23], s82 offen offset:0 sc1
    buffer_load_dwordx4 v[144:147], v2, s[20:23], s82 offen offset:1024 sc1
    buffer_load_dwordx4 v[148:151], v2, s[20:23], s82 offen offset:2048 sc1
    buffer_load_dwordx4 v[152:155], v2, s[20:23], s82 offen offset:3072 sc1
    buffer_load_dwordx4 v[156:159], v2, s[20:23], s83 offen offset:0 sc1
    buffer_load_dwordx4 v[160:163], v2, s[20:23], s83 offen offset:1024 sc1
    s_waitcnt vmcnt(0)
    s_branch k2_oc1
k2_or2:
    s_cmp_eq_u32 s84, 0
    s_cbranch_scc1 k2_og2
    s_sub_u32 s84, s84, 1
    s_sleep 2
    buffer_load_dwordx4 v[132:135], v2, s[20:23], s74 offen offset:2048 sc1
    buffer_load_dwordx4 v[136:139], v2, s[20:23], s74 offen offset:3072 sc1
    buffer_load_dwordx4 v[140:143], v2, s[20:23], s82 offen offset:0 sc1
    buffer_load_dwordx4 v[144:147], v2, s[20:23], s82 offen offset:1024 sc1
    buffer_load_dwordx4 v[148:151], v2, s[20:23], s82 offen offset:2048 sc1
    buffer_load_dwordx4 v[152:155], v2, s[20:23], s82 offen offset:3072 sc1
    buffer_load_dwordx4 v[156:159], v2, s[20:23], s83 offen offset:0 sc1
    buffer_load_dwordx4 v[160:163], v2, s[20:23], s83 offen offset:1024 sc1
    s_waitcnt vmcnt(0)
    s_branch k2_oc2
k2_or3:
    s_cmp_eq_u32 s84, 0
    s_cbranch_scc1 k2_og3
    s_sub_u32 s84, s84, 1
    s_sleep 2
    buffer_load_dwordx4 v[136:139], v2, s[20:23], s74 offen offset:3072 sc1
    buffer_load_dwordx4 v[140:143], v2, s[20:23], s82 offen offset:0 sc1
    buffer_load_dwordx4 v[144:147], v2, s[20:23], s82 offen offset:1024 sc1
    buffer_load_dwordx4 v[148:151], v2, s[20:23], s82 offen offset:2048 sc1
    buffer_load_dwordx4 v[152:155], v2, s[20:23], s82 offen offset:3072 sc1
    buffer_load_dwordx4 v[156:159], v2, s[20:23], s83 offen offset:0 sc1
    buffer_load_dwordx4 v[160:163], v2, s[20:23], s83 offen offset:1024 sc1
    s_waitcnt vmcnt(0)
    s_branch k2_oc3
k2_or4:
    s_cmp_eq_u32 s84, 0
    s_cbranch_scc1 k2_og4
    s_sub_u32 s84, s84, 1
    s_sleep 2
    buffer_load_dwordx4 v[140:143], v2, s[20:23], s82 offen offset:0 sc1
    buffer_load_dwordx4 v[144:147], v2, s[20:23], s82 offen offset:1024 sc1
    buffer_load_dwordx4 v[148:151], v2, s[20:23], s82 offen offset:2048 sc1
    buffer_load_dwordx4 v[152:155], v2, s[20:23], s82 offen offset:3072 sc1
    buffer_load_dwordx4 v[156:159], v2, s[20:23], s83 offen offset:0 sc1
    buffer_load_dwordx4 v[160:163], v2, s[20:23], s83 offen offset:1024 sc1
    s_waitcnt vmcnt(0)
    s_branch k2_oc4
k2_or5:
    s_cmp_eq_u32 s84, 0
    s_cbranch_scc1 k2_og5
    s_sub_u32 s84, s84, 1
    s_sleep 2
    buffer_load_dwordx4 v[144:147], v2, s[20:23], s82 offen offset:1024 sc1
    buffer_load_dwordx4 v[148:151], v2, s[20:23], s82 offen offset:2048 sc1
    buffer_load_dwordx4 v[152:155], v2, s[20:23], s82 offen offset:3072 sc1
    buffer_load_dwordx4 v[156:159], v2, s[20:23], s83 offen offset:0 sc1
    buffer_load_dwordx4 v[160:163], v2, s[20:23], s83 offen offset:1024 sc1
    s_waitcnt vmcnt(0)
    s_branch k2_oc5
k2_or6:
    s_cmp_eq_u32 s84, 0
    s_cbranch_scc1 k2_og6
    s_sub_u32 s84, s84, 1
    s_sleep 2
    buffer_load_dwordx4 v[148:151], v2, s[20:23], s82 offen offset:2048 sc1
    buffer_load_dwordx4 v[152:155], v2, s[20:23], s82 offen offset:3072 sc1
    buffer_load_dwordx4 v[156:159], v2, s[20:23], s83 offen offset:0 sc1
    buffer_load_dwordx4 v[160:163], v2, s[20:23], s83 offen offset:1024 sc1
    s_waitcnt vmcnt(0)
    s_branch k2_oc6
k2_or7:
    s_cmp_eq_u32 s84, 0
    s_cbranch_scc1 k2_og7
    s_sub_u32 s84, s84, 1
    s_sleep 2
    buffer_load_dwordx4 v[152:155], v2, s[20:23], s82 offen offset:3072 sc1
    buffer_load_dwordx4 v[156:159], v2, s[20:23], s83 offen offset:0 sc1
    buffer_load_dwordx4 v[160:163], v2, s[20:23], s83 offen offset:1024 sc1
    s_waitcnt vmcnt(0)
    s_branch k2_oc7
k2_or8:
    s_cmp_eq_u32 s84, 0
    s_cbranch_scc1 k2_og8
    s_sub_u32 s84, s84, 1
    s_sleep 2
    buffer_load_dwordx4 v[156:159], v2, s[20:23], s83 offen offset:0 sc1
    buffer_load_dwordx4 v[160:163], v2, s[20:23], s83 offen offset:1024 sc1
    s_waitcnt vmcnt(0)
    s_branch k2_oc8
k2_or9:
    s_cmp_eq_u32 s84, 0
    s_cbranch_scc1 k2_og9
    s_sub_u32 s84, s84, 1
    s_sleep 2
    buffer_load_dwordx4 v[160:163], v2, s[20:23], s83 offen offset:1024 sc1
    s_waitcnt vmcnt(0)
    s_branch k2_oc9
k2_gw:
    ds_write_b32 v165, v166 offset:16
    s_waitcnt lgkmcnt(0)
    s_add_u32 m0, s81, 0
    s_add_u32 s93, s92, 0
    buffer_load_dwordx4 v2, s[20:23], s93 offen offset:0 sc1 lds
    buffer_load_dwordx4 v2, s[20:23], s93 offen offset:1024 sc1 lds
    buffer_load_dwordx4 v2, s[20:23], s93 offen offset:2048 sc1 lds
    buffer_load_dwordx4 v2, s[20:23], s93 offen offset:3072 sc1 lds
    s_add_u32 m0, s81, 4096
    s_add_u32 s93, s92, 4096
    buffer_load_dwordx4 v2, s[20:23], s93 offen offset:0 sc1 lds
    buffer_load_dwordx4 v2, s[20:23], s93 offen offset:1024 sc1 lds
    buffer_load_dwordx4 v2, s[20:23], s93 offen offset:2048 sc1 lds
    buffer_load_dwordx4 v2, s[20:23], s93 offen offset:3072 sc1 lds
    s_add_u32 m0, s81, 8192
    s_add_u32 s93, s92, 8192
    buffer_load_dwordx4 v2, s[20:23], s93 offen offset:0 sc1 lds
    buffer_load_dwordx4 v2, s[20:23], s93 offen offset:1024 sc1 lds
    s_add_u32 m0, s81, 10240
    s_add_u32 s93, s92, 151552
    buffer_load_dwordx4 v2, s[20:23], s93 offen offset:0 sc1 lds
    buffer_load_dwordx4 v2, s[20:23], s93 offen offset:1024 sc1 lds
    buffer_load_dwordx4 v2, s[20:23], s93 offen offset:2048 sc1 lds
    buffer_load_dwordx4 v2, s[20:23], s93 offen offset:3072 sc1 lds
    s_add_u32 m0, s81, 14336
    s_add_u32 s93, s92, 155648
    buffer_load_dwordx4 v2, s[20:23], s93 offen offset:0 sc1 lds
    buffer_load_dwordx4 v2, s[20:23], s93 offen offset:1024 sc1 lds
    buffer_load_dwordx4 v2, s[20:23], s93 offen offset:2048 sc1 lds
    buffer_load_dwordx4 v2, s[20:23], s93 offen offset:3072 sc1 lds
    s_add_u32 m0, s81, 18432
    s_add_u32 s93, s92, 159744
    buffer_load_dwordx4 v2, s[20:23], s93 offen offset:0 sc1 lds
    buffer_load_dwordx4 v2, s[20:23], s93 offen offset:1024 sc1 lds
    s_add_u32 m0, s81, 20480
    s_add_u32 s93, s92, 303104
    buffer_load_dwordx4 v2, s[20:23], s93 offen offset:0 sc1 lds
    buffer_load_dwordx4 v2, s[20:23], s93 offen offset:1024 sc1 lds
    buffer_load_dwordx4 v2, s[20:23], s93 offen offset:2048 sc1 lds
    buffer_load_dwordx4 v2, s[20:23], s93 offen offset:3072 sc1 lds
    s_add_u32 m0, s81, 24576
    s_add_u32 s93, s92, 307200
    buffer_load_dwordx4 v2, s[20:23], s93 offen offset:0 sc1 lds
    buffer_load_dwordx4 v2, s[20:23], s93 offen offset:1024 sc1 lds
    buffer_load_dwordx4 v2, s[20:23], s93 offen offset:2048 sc1 lds
    buffer_load_dwordx4 v2, s[20:23], s93 offen offset:3072 sc1 lds
    s_add_u32 m0, s81, 28672
    s_add_u32 s93, s92, 311296
    buffer_load_dwordx4 v2, s[20:23], s93 offen offset:0 sc1 lds
    buffer_load_dwordx4 v2, s[20:23], s93 offen offset:1024 sc1 lds
    s_mov_b32 s95, 1
    s_setprio 3
    s_branch k2_gnext
k2_attn:
    s_cmp_eq_u32 s76, 33554432
    s_cbranch_scc1 k2_noqf
    v_mov_b32 v3, 1
    s_waitcnt vmcnt(0)
    s_mov_b64 exec, 1
    buffer_store_dword v3, v2, s[20:23], s76 offen sc1
    s_mov_b64 exec, -1
k2_noqf:
    s_waitcnt lgkmcnt(0)
    s_barrier
    s_and_b32 s82, s2, 7
    s_lshr_b32 s83, s2, 3
    s_lshl_b32 s65, s82, 3
    s_lshr_b32 s84, s83, 2
    s_add_u32 s65, s65, s84
    s_and_b32 s66, s83, 3
    s_and_b32 s67, s64, 3
    s_setprio 1
    s_lshr_b32 s68, s64, 3
    s_lshl_b32 s82, s66, 2
    s_add_u32 s82, s82, s67
    s_mul_i32 s82, s82, 10
    s_lshr_b32 s82, s82, 2
    s_lshl_b32 s82, s82, 10
    v_and_b32 v121, 31, v1
    v_lshrrev_b32 v122, 5, v1
    s_mul_i32 s83, s65, 40960
    s_add_u32 s83, s83, s82
    s_add_u32 s83, s83, 7340032
    v_lshlrev_b32 v127, 2, v1
    s_mov_b32 s4, s40
    s_mov_b32 s5, s41
    s_mov_b32 s6, 2621440
    s_mov_b32 s7, 0x20000
    s_mov_b32 s8, s58
    s_mov_b32 s9, s59
    s_mov_b32 s10, 2621440
    s_mov_b32 s11, 0x20000
    s_mul_i32 s85, s68, 81920
    v_add_u32 v9, s85, v2
    v_add_u32 v10, 1024, v127
    v_add_u32 v10, s85, v10
    v_min_u32 v121, 19, v121
    v_lshlrev_b32 v11, 4, v121
    v_mul_u32_u24 v122, 320, v122
    v_add_u32 v11, v11, v122
    v_add_u32 v11, 1280, v11
    v_add_u32 v11, s85, v11
    s_mov_b32 s70, 0xfffff
    s_mov_b32 s71, 0xfffff
    s_mov_b32 s69, 0
    s_mov_b32 s72, 2
    v_mov_b32 v29, 0x3f803f80
    v_mov_b32 v21, 0
    v_mov_b32 v23, 0
    v_mov_b32 v140, 0xffff0000
    v_mov_b32 v32, 0
    v_mov_b32 v33, 0
    v_mov_b32 v34, 0
    v_mov_b32 v35, 0
    v_mov_b32 v36, 0
    v_mov_b32 v37, 0
    v_mov_b32 v38, 0
    v_mov_b32 v39, 0
    s_mov_b32 exec_lo, 0x100000
    s_mov_b32 exec_hi, 0x100000
    v_mov_b32 v32, 0x3f803f80
    v_mov_b32 v33, 0x3f803f80
    v_mov_b32 v34, 0x3f803f80
    v_mov_b32 v35, 0x3f803f80
    v_mov_b32 v36, 0x3f803f80
    v_mov_b32 v37, 0x3f803f80
    v_mov_b32 v38, 0x3f803f80
    v_mov_b32 v39, 0x3f803f80
    s_mov_b64 exec, -1
    v_mov_b32 v80, 0
    v_mov_b32 v81, 0
    v_mov_b32 v82, 0
    v_mov_b32 v83, 0
    v_mov_b32 v84, 0
    v_mov_b32 v85, 0
    v_mov_b32 v86, 0
    v_mov_b32 v87, 0
    v_mov_b32 v88, 0
    v_mov_b32 v89, 0
    v_mov_b32 v90, 0
    v_mov_b32 v91, 0
    v_mov_b32 v92, 0
    v_mov_b32 v93, 0
    v_mov_b32 v94, 0
    v_mov_b32 v95, 0
    v_mov_b32 v96, 0
    v_mov_b32 v97, 0
    v_mov_b32 v98, 0
    v_mov_b32 v99, 0
    v_mov_b32 v100, 0
    v_mov_b32 v101, 0
    v_mov_b32 v102, 0
    v_mov_b32 v103, 0
    v_mov_b32 v104, 0
    v_mov_b32 v105, 0
    v_mov_b32 v106, 0
    v_mov_b32 v107, 0
    v_mov_b32 v108, 0
    v_mov_b32 v109, 0
    v_mov_b32 v110, 0
    v_mov_b32 v111, 0
    v_mov_b32 v112, 0
    v_mov_b32 v113, 0
    v_mov_b32 v114, 0
    v_mov_b32 v115, 0
    v_mov_b32 v116, 0
    v_mov_b32 v117, 0
    v_mov_b32 v118, 0
    v_mov_b32 v119, 0
    s_mul_i32 s82, s67, 3072
    s_add_u32 s82, s82, 61440
    s_add_u32 s84, s82, s85
    s_sub_u32 s85, 81920, s85
    s_add_u32 s85, s85, s82
    v_add_u32 v7, s84, v2
    v_add_u32 v8, s85, v2
    s_lshl_b32 s86, s66, 3
    s_lshl_b32 s87, s67, 1
    s_add_u32 s86, s86, s87
    s_add_u32 s86, s86, s68
    s_mul_i32 s82, s65, 40
    s_add_u32 s77, s82, s86
    s_lshl_b32 s77, s77, 10
    s_add_u32 s77, s77, 15728640
    s_lshr_b32 s78, s86, 2
    s_add_u32 s78, s78, s82
    s_lshl_b32 s78, s78, 10
    s_and_b32 s85, s86, 2
    s_lshl_b32 s85, s85, 8
    s_add_u32 s78, s78, s85
    s_and_b32 s85, s86, 1
    s_lshl_b32 s85, s85, 3
    s_add_u32 s78, s78, s85
    s_add_u32 s78, s78, 15761408
    s_lshl_b32 s80, s64, 2
    v_mov_b32 v4, s80
    s_mul_i32 s79, s68, 81920
    s_add_u32 s79, s79, 10485760
    v_and_b32 v6, 12, v127
    v_mov_b32 v139, 1
    v_mov_b32 v136, 80384
    s_barrier
    s_bitcmp1_b32 s67, 0
    s_cbranch_scc1 k2_qodd
    buffer_load_dwordx4 v[144:147], v2, s[20:23], s83 offen sc1
    buffer_load_dwordx4 v[148:151], v2, s[20:23], s83 offen offset:1024 sc1
    buffer_load_dwordx2 v[152:153], v2, s[20:23], s83 offen offset:2048 sc1
    s_branch k2_qld
k2_qodd:
    buffer_load_dwordx2 v[144:145], v2, s[20:23], s83 offen offset:8 sc1
    buffer_load_dwordx4 v[146:149], v2, s[20:23], s83 offen offset:1024 sc1
    buffer_load_dwordx4 v[150:153], v2, s[20:23], s83 offen offset:2048 sc1
k2_qld:
    buffer_load_dwordx4 v[156:159], v2, s[20:23], s79 offen sc1
    ds_read_b32 v135, v136
    s_waitcnt vmcnt(0) lgkmcnt(0)
    v_mov_b32 v16, v150
    v_mov_b32 v17, v151
    v_mov_b32 v18, v150
    v_mov_b32 v19, v151
    v_mov_b32 v12, v144
    v_mov_b32 v13, v145
    v_permlane32_swap_b32 v148, v16
    v_permlane32_swap_b32 v149, v17
    v_permlane32_swap_b32 v18, v152
    v_permlane32_swap_b32 v19, v153
    v_mov_b32 v14, v146
    v_mov_b32 v15, v147
    v_permlane32_swap_b32 v16, v18
    v_permlane32_swap_b32 v17, v19
    v_permlane32_swap_b32 v148, v149
    v_permlane32_swap_b32 v152, v153
    v_mov_b32 v20, v148
    v_mov_b32 v22, v153
    s_cmp_eq_u32 s68, 1
    s_cbranch_scc1 k2_qns
    v_swap_b32 v12, v16
    v_swap_b32 v13, v17
    v_swap_b32 v14, v18
    v_swap_b32 v15, v19
    v_swap_b32 v20, v22
k2_qns:
    v_dot2_f32_bf16 v128, v12, v12, 0
    v_dot2_f32_bf16 v130, v16, v16, 0
    v_dot2_f32_bf16 v128, v13, v13, v128
    v_dot2_f32_bf16 v130, v17, v17, v130
    v_dot2_f32_bf16 v128, v14, v14, v128
    v_dot2_f32_bf16 v130, v18, v18, v130
    v_dot2_f32_bf16 v128, v15, v15, v128
    v_dot2_f32_bf16 v130, v19, v19, v130
    v_dot2_f32_bf16 v128, v20, v20, v128
    v_dot2_f32_bf16 v130, v22, v22, v130
    s_nop 2
    v_mov_b32 v129, v128
    v_mov_b32 v131, v130
    s_nop 1
    v_permlane32_swap_b32 v128, v129
    v_permlane32_swap_b32 v130, v131
    v_add_f32 v128, v128, v129
    v_add_f32 v130, v130, v131
    v_mul_f32 v128, v135, v128
    v_mul_f32 v130, v135, v130
    v_sqrt_f32 v128, v128
    v_sqrt_f32 v130, v130
    v_mul_f32 v128, 0x3f840000, v128
    v_mul_f32 v130, 0x3f840000, v130
    v_mov_b32 v125, 0x42480000
    v_cmp_nge_f32 vcc, v125, v128
    v_cmp_nge_f32 s[84:85], v125, v130
    s_nop 1
    s_or_b64 vcc, vcc, s[84:85]
    s_barrier
    s_cbranch_vccnz k2_fb0
k2_shift:
    ds_read_b32 v28, v10
    v_mov_b32 v24, v156
    v_mov_b32 v25, v157
    v_mov_b32 v26, v158
    v_mov_b32 v27, v159
    v_xor_b32 v128, 0x80000000, v128
    v_and_b32 v129, v140, v128
    v_sub_f32 v128, v128, v129
    v_lshrrev_b32 v128, 16, v128
    v_xor_b32 v130, 0x80000000, v130
    v_and_b32 v131, v140, v130
    v_sub_f32 v130, v130, v131
    v_lshrrev_b32 v130, 16, v130
    s_mov_b32 exec_hi, 0
    v_or_b32 v21, v128, v129
    v_or_b32 v23, v130, v131
    s_mov_b64 exec, -1
    s_waitcnt lgkmcnt(0)
    v_mfma_f32_32x32x16_bf16 v[40:55], v[24:27], v[12:15], 0
    v_mfma_f32_32x32x8_bf16 v[40:55], v[28:29], v[20:21], v[40:55]
    s_nop 7
    s_cmp_eq_u32 s68, 0
    s_cbranch_scc1 k2_atopO
k2_atopY:
    s_cmp_eq_u32 s69, s72
    s_cbranch_scc1 k2_abarY
k2_abar_rY:
    v_mfma_f32_32x32x16_bf16 v[56:71], v[24:27], v[16:19], 0
    v_exp_f32 v40, v40
    v_exp_f32 v41, v41
    v_exp_f32 v42, v42
    v_exp_f32 v43, v43
    v_mfma_f32_32x32x8_bf16 v[56:71], v[28:29], v[22:23], v[56:71]
    s_setprio 1
    ds_read_b128 v[24:27], v9 offset:2560
    ds_read_b32 v28, v10 offset:2560
    v_exp_f32 v44, v44
    v_exp_f32 v45, v45
    v_exp_f32 v46, v46
    v_exp_f32 v47, v47
    v_cvt_pk_bf16_f32 v72, v40, v41
    v_cvt_pk_bf16_f32 v73, v42, v43
    v_cvt_pk_bf16_f32 v74, v44, v45
    v_cvt_pk_bf16_f32 v75, v46, v47
    v_mfma_f32_32x32x16_bf16 v[104:119], v[32:35], v[80:83], v[104:119]
    v_exp_f32 v48, v48
    v_exp_f32 v49, v49
    v_exp_f32 v50, v50
    v_exp_f32 v51, v51
    v_mfma_f32_32x32x16_bf16 v[104:119], v[36:39], v[84:87], v[104:119]
    s_mov_b64 exec, s[70:71]
    ds_read_b128 v[32:35], v11 offset:0
    ds_read_b128 v[36:39], v11 offset:640
    s_mov_b64 exec, -1
    v_exp_f32 v52, v52
    v_exp_f32 v53, v53
    v_exp_f32 v54, v54
    v_exp_f32 v55, v55
    v_cvt_pk_bf16_f32 v76, v48, v49
    v_cvt_pk_bf16_f32 v77, v50, v51
    v_cvt_pk_bf16_f32 v78, v52, v53
    v_cvt_pk_bf16_f32 v79, v54, v55
    s_waitcnt lgkmcnt(2)
    v_mfma_f32_32x32x16_bf16 v[40:55], v[24:27], v[12:15], 0
    s_setprio 2
    v_exp_f32 v56, v56
    v_exp_f32 v57, v57
    v_exp_f32 v58, v58
    v_exp_f32 v59, v59
    v_mfma_f32_32x32x8_bf16 v[40:55], v[28:29], v[20:21], v[40:55]
    v_exp_f32 v60, v60
    v_exp_f32 v61, v61
    v_exp_f32 v62, v62
    v_exp_f32 v63, v63
    v_cvt_pk_bf16_f32 v80, v56, v57
    v_cvt_pk_bf16_f32 v81, v58, v59
    v_cvt_pk_bf16_f32 v82, v60, v61
    v_cvt_pk_bf16_f32 v83, v62, v63
    s_waitcnt lgkmcnt(0)
    v_mfma_f32_32x32x16_bf16 v[88:103], v[32:35], v[72:75], v[88:103]
    v_exp_f32 v64, v64
    v_exp_f32 v65, v65
    v_exp_f32 v66, v66
    v_exp_f32 v67, v67
    v_mfma_f32_32x32x16_bf16 v[88:103], v[36:39], v[76:79], v[88:103]
    v_exp_f32 v68, v68
    v_exp_f32 v69, v69
    v_exp_f32 v70, v70
    v_exp_f32 v71, v71
    v_cvt_pk_bf16_f32 v84, v64, v65
    v_cvt_pk_bf16_f32 v85, v66, v67
    v_cvt_pk_bf16_f32 v86, v68, v69
    v_cvt_pk_bf16_f32 v87, v70, v71
    v_mfma_f32_32x32x16_bf16 v[56:71], v[24:27], v[16:19], 0
    v_exp_f32 v40, v40
    v_exp_f32 v41, v41
    v_exp_f32 v42, v42
    v_exp_f32 v43, v43
    v_mfma_f32_32x32x8_bf16 v[56:71], v[28:29], v[22:23], v[56:71]
    ds_read_b128 v[24:27], v9 offset:5120
    ds_read_b32 v28, v10 offset:5120
    v_exp_f32 v44, v44
    v_exp_f32 v45, v45
    v_exp_f32 v46, v46
    v_exp_f32 v47, v47
    v_cvt_pk_bf16_f32 v72, v40, v41
    v_cvt_pk_bf16_f32 v73, v42, v43
    v_cvt_pk_bf16_f32 v74, v44, v45
    v_cvt_pk_bf16_f32 v75, v46, v47
    v_mfma_f32_32x32x16_bf16 v[104:119], v[32:35], v[80:83], v[104:119]
    v_exp_f32 v48, v48
    v_exp_f32 v49, v49
    v_exp_f32 v50, v50
    v_exp_f32 v51, v51
    v_mfma_f32_32x32x16_bf16 v[104:119], v[36:39], v[84:87], v[104:119]
    s_mov_b64 exec, s[70:71]
    ds_read_b128 v[32:35], v11 offset:2560
    ds_read_b128 v[36:39], v11 offset:3200
    s_mov_b64 exec, -1
    v_exp_f32 v52, v52
    v_exp_f32 v53, v53
    v_exp_f32 v54, v54
    v_exp_f32 v55, v55
    v_cvt_pk_bf16_f32 v76, v48, v49
    v_cvt_pk_bf16_f32 v77, v50, v51
    v_cvt_pk_bf16_f32 v78, v52, v53
    v_cvt_pk_bf16_f32 v79, v54, v55
    s_waitcnt lgkmcnt(2)
    v_mfma_f32_32x32x16_bf16 v[40:55], v[24:27], v[12:15], 0
    v_exp_f32 v56, v56
    v_exp_f32 v57, v57
    v_exp_f32 v58, v58
    v_exp_f32 v59, v59
    v_mfma_f32_32x32x8_bf16 v[40:55], v[28:29], v[20:21], v[40:55]
    v_exp_f32 v60, v60
    v_exp_f32 v61, v61
    v_exp_f32 v62, v62
    v_exp_f32 v63, v63
    v_cvt_pk_bf16_f32 v80, v56, v57
    v_cvt_pk_bf16_f32 v81, v58, v59
    v_cvt_pk_bf16_f32 v82, v60, v61
    v_cvt_pk_bf16_f32 v83, v62, v63
    s_waitcnt lgkmcnt(0)
    v_mfma_f32_32x32x16_bf16 v[88:103], v[32:35], v[72:75], v[88:103]
    v_exp_f32 v64, v64
    v_exp_f32 v65, v65
    v_exp_f32 v66, v66
    v_exp_f32 v67, v67
    v_mfma_f32_32x32x16_bf16 v[88:103], v[36:39], v[76:79], v[88:103]
    v_exp_f32 v68, v68
    v_exp_f32 v69, v69
    v_exp_f32 v70, v70
    v_exp_f32 v71, v71
    v_cvt_pk_bf16_f32 v84, v64, v65
    v_cvt_pk_bf16_f32 v85, v66, v67
    v_cvt_pk_bf16_f32 v86, v68, v69
    v_cvt_pk_bf16_f32 v87, v70, v71
    v_mfma_f32_32x32x16_bf16 v[56:71], v[24:27], v[16:19], 0
    v_exp_f32 v40, v40
    v_exp_f32 v41, v41
    v_exp_f32 v42, v42
    v_exp_f32 v43, v43
    v_mfma_f32_32x32x8_bf16 v[56:71], v[28:29], v[22:23], v[56:71]
    s_setprio 1
    ds_read_b128 v[24:27], v9 offset:7680
    ds_read_b32 v28, v10 offset:7680
    v_exp_f32 v44, v44
    v_exp_f32 v45, v45
    v_exp_f32 v46, v46
    v_exp_f32 v47, v47
    v_cvt_pk_bf16_f32 v72, v40, v41
    v_cvt_pk_bf16_f32 v73, v42, v43
    v_cvt_pk_bf16_f32 v74, v44, v45
    v_cvt_pk_bf16_f32 v75, v46, v47
    v_mfma_f32_32x32x16_bf16 v[104:119], v[32:35], v[80:83], v[104:119]
    v_exp_f32 v48, v48
    v_exp_f32 v49, v49
    v_exp_f32 v50, v50
    v_exp_f32 v51, v51
    v_mfma_f32_32x32x16_bf16 v[104:119], v[36:39], v[84:87], v[104:119]
    s_mov_b64 exec, s[70:71]
    ds_read_b128 v[32:35], v11 offset:5120
    ds_read_b128 v[36:39], v11 offset:5760
    s_mov_b64 exec, -1
    v_exp_f32 v52, v52
    v_exp_f32 v53, v53
    v_exp_f32 v54, v54
    v_exp_f32 v55, v55
    v_cvt_pk_bf16_f32 v76, v48, v49
    v_cvt_pk_bf16_f32 v77, v50, v51
    v_cvt_pk_bf16_f32 v78, v52, v53
    v_cvt_pk_bf16_f32 v79, v54, v55
    s_waitcnt lgkmcnt(2)
    v_mfma_f32_32x32x16_bf16 v[40:55], v[24:27], v[12:15], 0
    s_setprio 2
    v_exp_f32 v56, v56
    v_exp_f32 v57, v57
    v_exp_f32 v58, v58
    v_exp_f32 v59, v59
    v_mfma_f32_32x32x8_bf16 v[40:55], v[28:29], v[20:21], v[40:55]
    v_exp_f32 v60, v60
    v_exp_f32 v61, v61
    v_exp_f32 v62, v62
    v_exp_f32 v63, v63
    v_cvt_pk_bf16_f32 v80, v56, v57
    v_cvt_pk_bf16_f32 v81, v58, v59
    v_cvt_pk_bf16_f32 v82, v60, v61
    v_cvt_pk_bf16_f32 v83, v62, v63
    s_waitcnt lgkmcnt(0)
    v_mfma_f32_32x32x16_bf16 v[88:103], v[32:35], v[72:75], v[88:103]
    v_exp_f32 v64, v64
    v_exp_f32 v65, v65
    v_exp_f32 v66, v66
    v_exp_f32 v67, v67
    v_mfma_f32_32x32x16_bf16 v[88:103], v[36:39], v[76:79], v[88:103]
    v_exp_f32 v68, v68
    v_exp_f32 v69, v69
    v_exp_f32 v70, v70
    v_exp_f32 v71, v71
    v_cvt_pk_bf16_f32 v84, v64, v65
    v_cvt_pk_bf16_f32 v85, v66, v67
    v_cvt_pk_bf16_f32 v86, v68, v69
    v_cvt_pk_bf16_f32 v87, v70, v71
    v_mfma_f32_32x32x16_bf16 v[56:71], v[24:27], v[16:19], 0
    v_exp_f32 v40, v40
    v_exp_f32 v41, v41
    v_exp_f32 v42, v42
    v_exp_f32 v43, v43
    v_mfma_f32_32x32x8_bf16 v[56:71], v[28:29], v[22:23], v[56:71]
    ds_read_b128 v[24:27], v9 offset:10240
    ds_read_b32 v28, v10 offset:10240
    v_exp_f32 v44, v44
    v_exp_f32 v45, v45
    v_exp_f32 v46, v46
    v_exp_f32 v47, v47
    v_cvt_pk_bf16_f32 v72, v40, v41
    v_cvt_pk_bf16_f32 v73, v42, v43
    v_cvt_pk_bf16_f32 v74, v44, v45
    v_cvt_pk_bf16_f32 v75, v46, v47
    v_mfma_f32_32x32x16_bf16 v[104:119], v[32:35], v[80:83], v[104:119]
    v_exp_f32 v48, v48
    v_exp_f32 v49, v49
    v_exp_f32 v50, v50
    v_exp_f32 v51, v51
    v_mfma_f32_32x32x16_bf16 v[104:119], v[36:39], v[84:87], v[104:119]
    s_mov_b64 exec, s[70:71]
    ds_read_b128 v[32:35], v11 offset:7680
    ds_read_b128 v[36:39], v11 offset:8320
    s_mov_b64 exec, -1
    v_exp_f32 v52, v52
    v_exp_f32 v53, v53
    v_exp_f32 v54, v54
    v_exp_f32 v55, v55
    v_cvt_pk_bf16_f32 v76, v48, v49
    v_cvt_pk_bf16_f32 v77, v50, v51
    v_cvt_pk_bf16_f32 v78, v52, v53
    v_cvt_pk_bf16_f32 v79, v54, v55
    s_waitcnt lgkmcnt(2)
    v_mfma_f32_32x32x16_bf16 v[40:55], v[24:27], v[12:15], 0
    v_exp_f32 v56, v56
    v_exp_f32 v57, v57
    v_exp_f32 v58, v58
    v_exp_f32 v59, v59
    v_mfma_f32_32x32x8_bf16 v[40:55], v[28:29], v[20:21], v[40:55]
    v_exp_f32 v60, v60
    v_exp_f32 v61, v61
    v_exp_f32 v62, v62
    v_exp_f32 v63, v63
    v_cvt_pk_bf16_f32 v80, v56, v57
    v_cvt_pk_bf16_f32 v81, v58, v59
    v_cvt_pk_bf16_f32 v82, v60, v61
    v_cvt_pk_bf16_f32 v83, v62, v63
    s_waitcnt lgkmcnt(0)
    v_mfma_f32_32x32x16_bf16 v[88:103], v[32:35], v[72:75], v[88:103]
    v_exp_f32 v64, v64
    v_exp_f32 v65, v65
    v_exp_f32 v66, v66
    v_exp_f32 v67, v67
    v_mfma_f32_32x32x16_bf16 v[88:103], v[36:39], v[76:79], v[88:103]
    v_add_u32 v9, 10240, v9
    v_add_u32 v10, 10240, v10
    v_add_u32 v11, 10240, v11
    s_add_u32 s69, s69, 1
    s_cmp_lt_u32 s69, 8
    v_exp_f32 v68, v68
    v_exp_f32 v69, v69
    v_exp_f32 v70, v70
    v_exp_f32 v71, v71
    v_cvt_pk_bf16_f32 v84, v64, v65
    v_cvt_pk_bf16_f32 v85, v66, v67
    v_cvt_pk_bf16_f32 v86, v68, v69
    v_cvt_pk_bf16_f32 v87, v70, v71
    s_cbranch_scc1 k2_atopY
    s_branch k2_aend
k2_atopO:
    s_cmp_eq_u32 s69, s72
    s_cbranch_scc1 k2_abarO
k2_abar_rO:
    v_mfma_f32_32x32x16_bf16 v[56:71], v[24:27], v[16:19], 0
    v_exp_f32 v40, v40
    v_exp_f32 v41, v41
    v_exp_f32 v42, v42
    v_exp_f32 v43, v43
    v_mfma_f32_32x32x8_bf16 v[56:71], v[28:29], v[22:23], v[56:71]
    ds_read_b128 v[24:27], v9 offset:2560
    ds_read_b32 v28, v10 offset:2560
    v_exp_f32 v44, v44
    v_exp_f32 v45, v45
    v_exp_f32 v46, v46
    v_exp_f32 v47, v47
    v_cvt_pk_bf16_f32 v72, v40, v41
    v_cvt_pk_bf16_f32 v73, v42, v43
    v_cvt_pk_bf16_f32 v74, v44, v45
    v_cvt_pk_bf16_f32 v75, v46, v47
    v_mfma_f32_32x32x16_bf16 v[104:119], v[32:35], v[80:83], v[104:119]
    v_exp_f32 v48, v48
    v_exp_f32 v49, v49
    v_exp_f32 v50, v50
    v_exp_f32 v51, v51
    v_mfma_f32_32x32x16_bf16 v[104:119], v[36:39], v[84:87], v[104:119]
    s_mov_b64 exec, s[70:71]
    ds_read_b128 v[32:35], v11 offset:0
    ds_read_b128 v[36:39], v11 offset:640
    s_mov_b64 exec, -1
    v_exp_f32 v52, v52
    v_exp_f32 v53, v53
    v_exp_f32 v54, v54
    v_exp_f32 v55, v55
    v_cvt_pk_bf16_f32 v76, v48, v49
    v_cvt_pk_bf16_f32 v77, v50, v51
    v_cvt_pk_bf16_f32 v78, v52, v53
    v_cvt_pk_bf16_f32 v79, v54, v55
    s_waitcnt lgkmcnt(2)
    v_mfma_f32_32x32x16_bf16 v[40:55], v[24:27], v[12:15], 0
    v_exp_f32 v56, v56
    v_exp_f32 v57, v57
    v_exp_f32 v58, v58
    v_exp_f32 v59, v59
    v_mfma_f32_32x32x8_bf16 v[40:55], v[28:29], v[20:21], v[40:55]
    v_exp_f32 v60, v60
    v_exp_f32 v61, v61
    v_exp_f32 v62, v62
    v_exp_f32 v63, v63
    v_cvt_pk_bf16_f32 v80, v56, v57
    v_cvt_pk_bf16_f32 v81, v58, v59
    v_cvt_pk_bf16_f32 v82, v60, v61
    v_cvt_pk_bf16_f32 v83, v62, v63
    s_waitcnt lgkmcnt(0)
    v_mfma_f32_32x32x16_bf16 v[88:103], v[32:35], v[72:75], v[88:103]
    v_exp_f32 v64, v64
    v_exp_f32 v65, v65
    v_exp_f32 v66, v66
    v_exp_f32 v67, v67
    v_mfma_f32_32x32x16_bf16 v[88:103], v[36:39], v[76:79], v[88:103]
    v_exp_f32 v68, v68
    v_exp_f32 v69, v69
    v_exp_f32 v70, v70
    v_exp_f32 v71, v71
    v_cvt_pk_bf16_f32 v84, v64, v65
    v_cvt_pk_bf16_f32 v85, v66, v67
    v_cvt_pk_bf16_f32 v86, v68, v69
    v_cvt_pk_bf16_f32 v87, v70, v71
    v_mfma_f32_32x32x16_bf16 v[56:71], v[24:27], v[16:19], 0
    v_exp_f32 v40, v40
    v_exp_f32 v41, v41
    v_exp_f32 v42, v42
    v_exp_f32 v43, v43
    v_mfma_f32_32x32x8_bf16 v[56:71], v[28:29], v[22:23], v[56:71]
    ds_read_b128 v[24:27], v9 offset:5120
    ds_read_b32 v28, v10 offset:5120
    v_exp_f32 v44, v44
    v_exp_f32 v45, v45
    v_exp_f32 v46, v46
    v_exp_f32 v47, v47
    v_cvt_pk_bf16_f32 v72, v40, v41
    v_cvt_pk_bf16_f32 v73, v42, v43
    v_cvt_pk_bf16_f32 v74, v44, v45
    v_cvt_pk_bf16_f32 v75, v46, v47
    v_mfma_f32_32x32x16_bf16 v[104:119], v[32:35], v[80:83], v[104:119]
    v_exp_f32 v48, v48
    v_exp_f32 v49, v49
    v_exp_f32 v50, v50
    v_exp_f32 v51, v51
    v_mfma_f32_32x32x16_bf16 v[104:119], v[36:39], v[84:87], v[104:119]
    s_mov_b64 exec, s[70:71]
    ds_read_b128 v[32:35], v11 offset:2560
    ds_read_b128 v[36:39], v11 offset:3200
    s_mov_b64 exec, -1
    v_exp_f32 v52, v52
    v_exp_f32 v53, v53
    v_exp_f32 v54, v54
    v_exp_f32 v55, v55
    v_cvt_pk_bf16_f32 v76, v48, v49
    v_cvt_pk_bf16_f32 v77, v50, v51
    v_cvt_pk_bf16_f32 v78, v52, v53
    v_cvt_pk_bf16_f32 v79, v54, v55
    s_waitcnt lgkmcnt(2)
    v_mfma_f32_32x32x16_bf16 v[40:55], v[24:27], v[12:15], 0
    v_exp_f32 v56, v56
    v_exp_f32 v57, v57
    v_exp_f32 v58, v58
    v_exp_f32 v59, v59
    v_mfma_f32_32x32x8_bf16 v[40:55], v[28:29], v[20:21], v[40:55]
    v_exp_f32 v60, v60
    v_exp_f32 v61, v61
    v_exp_f32 v62, v62
    v_exp_f32 v63, v63
    v_cvt_pk_bf16_f32 v80, v56, v57
    v_cvt_pk_bf16_f32 v81, v58, v59
    v_cvt_pk_bf16_f32 v82, v60, v61
    v_cvt_pk_bf16_f32 v83, v62, v63
    s_waitcnt lgkmcnt(0)
    v_mfma_f32_32x32x16_bf16 v[88:103], v[32:35], v[72:75], v[88:103]
    v_exp_f32 v64, v64
    v_exp_f32 v65, v65
    v_exp_f32 v66, v66
    v_exp_f32 v67, v67
    v_mfma_f32_32x32x16_bf16 v[88:103], v[36:39], v[76:79], v[88:103]
    v_exp_f32 v68, v68
    v_exp_f32 v69, v69
    v_exp_f32 v70, v70
    v_exp_f32 v71, v71
    v_cvt_pk_bf16_f32 v84, v64, v65
    v_cvt_pk_bf16_f32 v85, v66, v67
    v_cvt_pk_bf16_f32 v86, v68, v69
    v_cvt_pk_bf16_f32 v87, v70, v71
    v_mfma_f32_32x32x16_bf16 v[56:71], v[24:27], v[16:19], 0
    v_exp_f32 v40, v40
    v_exp_f32 v41, v41
    v_exp_f32 v42, v42
    v_exp_f32 v43, v43
    v_mfma_f32_32x32x8_bf16 v[56:71], v[28:29], v[22:23], v[56:71]
    ds_read_b128 v[24:27], v9 offset:7680
    ds_read_b32 v28, v10 offset:7680
    v_exp_f32 v44, v44
    v_exp_f32 v45, v45
    v_exp_f32 v46, v46
    v_exp_f32 v47, v47
    v_cvt_pk_bf16_f32 v72, v40, v41
    v_cvt_pk_bf16_f32 v73, v42, v43
    v_cvt_pk_bf16_f32 v74, v44, v45
    v_cvt_pk_bf16_f32 v75, v46, v47
    v_mfma_f32_32x32x16_bf16 v[104:119], v[32:35], v[80:83], v[104:119]
    v_exp_f32 v48, v48
    v_exp_f32 v49, v49
    v_exp_f32 v50, v50
    v_exp_f32 v51, v51
    v_mfma_f32_32x32x16_bf16 v[104:119], v[36:39], v[84:87], v[104:119]
    s_mov_b64 exec, s[70:71]
    ds_read_b128 v[32:35], v11 offset:5120
    ds_read_b128 v[36:39], v11 offset:5760
    s_mov_b64 exec, -1
    v_exp_f32 v52, v52
    v_exp_f32 v53, v53
    v_exp_f32 v54, v54
    v_exp_f32 v55, v55
    v_cvt_pk_bf16_f32 v76, v48, v49
    v_cvt_pk_bf16_f32 v77, v50, v51
    v_cvt_pk_bf16_f32 v78, v52, v53
    v_cvt_pk_bf16_f32 v79, v54, v55
    s_waitcnt lgkmcnt(2)
    v_mfma_f32_32x32x16_bf16 v[40:55], v[24:27], v[12:15], 0
    v_exp_f32 v56, v56
    v_exp_f32 v57, v57
    v_exp_f32 v58, v58
    v_exp_f32 v59, v59
    v_mfma_f32_32x32x8_bf16 v[40:55], v[28:29], v[20:21], v[40:55]
    v_exp_f32 v60, v60
    v_exp_f32 v61, v61
    v_exp_f32 v62, v62
    v_exp_f32 v63, v63
    v_cvt_pk_bf16_f32 v80, v56, v57
    v_cvt_pk_bf16_f32 v81, v58, v59
    v_cvt_pk_bf16_f32 v82, v60, v61
    v_cvt_pk_bf16_f32 v83, v62, v63
    s_waitcnt lgkmcnt(0)
    v_mfma_f32_32x32x16_bf16 v[88:103], v[32:35], v[72:75], v[88:103]
    v_exp_f32 v64, v64
    v_exp_f32 v65, v65
    v_exp_f32 v66, v66
    v_exp_f32 v67, v67
    v_mfma_f32_32x32x16_bf16 v[88:103], v[36:39], v[76:79], v[88:103]
    v_exp_f32 v68, v68
    v_exp_f32 v69, v69
    v_exp_f32 v70, v70
    v_exp_f32 v71, v71
    v_cvt_pk_bf16_f32 v84, v64, v65
    v_cvt_pk_bf16_f32 v85, v66, v67
    v_cvt_pk_bf16_f32 v86, v68, v69
    v_cvt_pk_bf16_f32 v87, v70, v71
    v_mfma_f32_32x32x16_bf16 v[56:71], v[24:27], v[16:19], 0
    v_exp_f32 v40, v40
    v_exp_f32 v41, v41
    v_exp_f32 v42, v42
    v_exp_f32 v43, v43
    v_mfma_f32_32x32x8_bf16 v[56:71], v[28:29], v[22:23], v[56:71]
    ds_read_b128 v[24:27], v9 offset:10240
    ds_read_b32 v28, v10 offset:10240
    v_exp_f32 v44, v44
    v_exp_f32 v45, v45
    v_exp_f32 v46, v46
    v_exp_f32 v47, v47
    v_cvt_pk_bf16_f32 v72, v40, v41
    v_cvt_pk_bf16_f32 v73, v42, v43
    v_cvt_pk_bf16_f32 v74, v44, v45
    v_cvt_pk_bf16_f32 v75, v46, v47
    v_mfma_f32_32x32x16_bf16 v[104:119], v[32:35], v[80:83], v[104:119]
    v_exp_f32 v48, v48
    v_exp_f32 v49, v49
    v_exp_f32 v50, v50
    v_exp_f32 v51, v51
    v_mfma_f32_32x32x16_bf16 v[104:119], v[36:39], v[84:87], v[104:119]
    s_mov_b64 exec, s[70:71]
    ds_read_b128 v[32:35], v11 offset:7680
    ds_read_b128 v[36:39], v11 offset:8320
    s_mov_b64 exec, -1
    v_exp_f32 v52, v52
    v_exp_f32 v53, v53
    v_exp_f32 v54, v54
    v_exp_f32 v55, v55
    v_cvt_pk_bf16_f32 v76, v48, v49
    v_cvt_pk_bf16_f32 v77, v50, v51
    v_cvt_pk_bf16_f32 v78, v52, v53
    v_cvt_pk_bf16_f32 v79, v54, v55
    s_waitcnt lgkmcnt(2)
    v_mfma_f32_32x32x16_bf16 v[40:55], v[24:27], v[12:15], 0
    v_exp_f32 v56, v56
    v_exp_f32 v57, v57
    v_exp_f32 v58, v58
    v_exp_f32 v59, v59
    v_mfma_f32_32x32x8_bf16 v[40:55], v[28:29], v[20:21], v[40:55]
    v_exp_f32 v60, v60
    v_exp_f32 v61, v61
    v_exp_f32 v62, v62
    v_exp_f32 v63, v63
    v_cvt_pk_bf16_f32 v80, v56, v57
    v_cvt_pk_bf16_f32 v81, v58, v59
    v_cvt_pk_bf16_f32 v82, v60, v61
    v_cvt_pk_bf16_f32 v83, v62, v63
    s_waitcnt lgkmcnt(0)
    v_mfma_f32_32x32x16_bf16 v[88:103], v[32:35], v[72:75], v[88:103]
    v_exp_f32 v64, v64
    v_exp_f32 v65, v65
    v_exp_f32 v66, v66
    v_exp_f32 v67, v67
    v_mfma_f32_32x32x16_bf16 v[88:103], v[36:39], v[76:79], v[88:103]
    v_add_u32 v9, 10240, v9
    v_add_u32 v10, 10240, v10
    v_add_u32 v11, 10240, v11
    s_add_u32 s69, s69, 1
    s_cmp_lt_u32 s69, 8
    v_exp_f32 v68, v68
    v_exp_f32 v69, v69
    v_exp_f32 v70, v70
    v_exp_f32 v71, v71
    v_cvt_pk_bf16_f32 v84, v64, v65
    v_cvt_pk_bf16_f32 v85, v66, v67
    v_cvt_pk_bf16_f32 v86, v68, v69
    v_cvt_pk_bf16_f32 v87, v70, v71
    s_cbranch_scc1 k2_atopO
k2_aend:
    s_nop 0
    v_mfma_f32_32x32x16_bf16 v[104:119], v[32:35], v[80:83], v[104:119]
    v_mfma_f32_32x32x16_bf16 v[104:119], v[36:39], v[84:87], v[104:119]
    s_barrier
    ds_write_b128 v7, v[88:91] offset:0
    ds_write_b128 v7, v[92:95] offset:1024
    ds_write_b128 v7, v[96:99] offset:2048
    s_waitcnt lgkmcnt(0)
    s_barrier
    ds_read_b128 v[64:67], v8 offset:2048
    ds_read_b128 v[56:59], v8
    ds_read_b128 v[60:63], v8 offset:1024
    s_nop 1
    s_waitcnt lgkmcnt(2)
    v_add_f32 v112, v112, v64
    v_add_f32 v113, v113, v65
    v_add_f32 v114, v114, v66
    v_add_f32 v115, v115, v67
    v_mov_b32 v120, v112
    v_mov_b32 v121, v112
    s_waitcnt lgkmcnt(0)
    v_add_f32 v104, v104, v56
    v_add_f32 v105, v105, v57
    v_permlane32_swap_b32 v120, v121
    v_rcp_f32 v121, v121
    v_add_f32 v106, v106, v58
    v_add_f32 v107, v107, v59
    v_add_f32 v108, v108, v60
    v_add_f32 v109, v109, v61
    v_add_f32 v110, v110, v62
    v_add_f32 v111, v111, v63
    v_mul_f32 v104, v104, v121
    v_mul_f32 v105, v105, v121
    v_mul_f32 v106, v106, v121
    v_mul_f32 v107, v107, v121
    v_mul_f32 v108, v108, v121
    v_mul_f32 v109, v109, v121
    v_mul_f32 v110, v110, v121
    v_mul_f32 v111, v111, v121
    v_cvt_pk_bf16_f32 v104, v104, v105
    v_cvt_pk_bf16_f32 v105, v106, v107
    v_cvt_pk_bf16_f32 v106, v108, v109
    v_cvt_pk_bf16_f32 v107, v110, v111
    v_min_u32 v104, -2, v104
    v_min_u32 v105, -2, v105
    v_min_u32 v106, -2, v106
    v_min_u32 v107, -2, v107
    v_mul_f32 v112, v112, v121
    v_mul_f32 v113, v113, v121
    v_mul_f32 v114, v114, v121
    v_mul_f32 v115, v115, v121
    v_cvt_pk_bf16_f32 v108, v112, v113
    v_cvt_pk_bf16_f32 v109, v114, v115
    v_min_u32 v108, -2, v108
    v_min_u32 v109, -2, v109
    s_cmp_eq_u32 s79, 1
    s_cbranch_scc1 k2_ost
    buffer_store_dwordx4 v[104:107], v2, s[20:23], s77 offen sc0 sc1
    s_mov_b32 exec_hi, 0
    buffer_store_dwordx2 v[108:109], v2, s[20:23], s78 offen sc0 sc1
    s_waitcnt vmcnt(0)
    s_branch k2_ost2
k2_ost:
    buffer_store_dwordx4 v[104:107], v2, s[20:23], s77 offen
    s_mov_b32 exec_hi, 0
    buffer_store_dwordx2 v[108:109], v2, s[20:23], s78 offen
k2_ost2:
    s_mov_b64 exec, -1
    v_subrev_u32 v0, 256, v0
    v_mul_u32_u24 v5, 3277, v0
    v_lshrrev_b32 v5, 16, v5
    v_mul_u32_u24 v6, 20, v5
    v_sub_u32 v6, v0, v6
    v_mul_u32_u24 v3, 1280, v5
    v_lshl_add_u32 v3, v6, 4, v3
    s_mul_i32 s82, s65, 40960
    s_mul_i32 s83, s66, 320
    s_add_u32 s82, s82, s83
    s_add_u32 s83, s82, 20480
    v_mul_u32_u24 v4, 144, v5
    v_lshrrev_b32 v5, 2, v6
    v_mul_u32_u24 v5, 4624, v5
    v_add_u32 v4, v4, v5
    v_and_b32 v6, 3, v6
    v_lshl_add_u32 v4, v6, 5, v4
    s_barrier
    s_cmp_ge_u32 s64, 9
    s_cbranch_scc1 k2_fin
    buffer_load_dwordx4 v[12:15], v3, s[4:7], s82 offen
    buffer_load_dwordx4 v[16:19], v3, s[4:7], s83 offen
    s_waitcnt vmcnt(0)
    v_lshlrev_b32 v24, 16, v12
    v_and_b32 v25, v140, v12
    v_lshlrev_b32 v26, 16, v13
    v_and_b32 v27, v140, v13
    v_lshlrev_b32 v28, 16, v14
    v_and_b32 v29, v140, v14
    v_lshlrev_b32 v30, 16, v15
    v_and_b32 v31, v140, v15
    v_lshlrev_b32 v32, 16, v16
    v_and_b32 v33, v140, v16
    v_lshlrev_b32 v34, 16, v17
    v_and_b32 v35, v140, v17
    v_lshlrev_b32 v36, 16, v18
    v_and_b32 v37, v140, v18
    v_lshlrev_b32 v38, 16, v19
    v_and_b32 v39, v140, v19
    v_add_u32 v5, 81920, v4
    s_barrier
    ds_read_b128 v[40:43], v4 offset:0
    ds_read_b128 v[44:47], v4 offset:16
    ds_read_b128 v[48:51], v4 offset:2304
    ds_read_b128 v[52:55], v4 offset:2320
    ds_read_b128 v[56:59], v4 offset:30720
    ds_read_b128 v[60:63], v4 offset:30736
    ds_read_b128 v[64:67], v4 offset:33024
    ds_read_b128 v[68:71], v4 offset:33040
    ds_read_b128 v[72:75], v5 offset:0
    ds_read_b128 v[76:79], v5 offset:16
    ds_read_b128 v[80:83], v5 offset:2304
    ds_read_b128 v[84:87], v5 offset:2320
    ds_read_b128 v[88:91], v5 offset:30720
    ds_read_b128 v[92:95], v5 offset:30736
    ds_read_b128 v[96:99], v5 offset:33024
    ds_read_b128 v[100:103], v5 offset:33040
    s_waitcnt lgkmcnt(12)
    v_add_f32 v24, v24, v40
    v_add_f32 v25, v25, v41
    v_add_f32 v26, v26, v42
    v_add_f32 v27, v27, v43
    v_add_f32 v28, v28, v44
    v_add_f32 v29, v29, v45
    v_add_f32 v30, v30, v46
    v_add_f32 v31, v31, v47
    v_add_f32 v32, v32, v48
    v_add_f32 v33, v33, v49
    v_add_f32 v34, v34, v50
    v_add_f32 v35, v35, v51
    v_add_f32 v36, v36, v52
    v_add_f32 v37, v37, v53
    v_add_f32 v38, v38, v54
    v_add_f32 v39, v39, v55
    s_waitcnt lgkmcnt(8)
    v_add_f32 v24, v24, v56
    v_add_f32 v25, v25, v57
    v_add_f32 v26, v26, v58
    v_add_f32 v27, v27, v59
    v_add_f32 v28, v28, v60
    v_add_f32 v29, v29, v61
    v_add_f32 v30, v30, v62
    v_add_f32 v31, v31, v63
    v_add_f32 v32, v32, v64
    v_add_f32 v33, v33, v65
    v_add_f32 v34, v34, v66
    v_add_f32 v35, v35, v67
    v_add_f32 v36, v36, v68
    v_add_f32 v37, v37, v69
    v_add_f32 v38, v38, v70
    v_add_f32 v39, v39, v71
    s_waitcnt lgkmcnt(4)
    v_add_f32 v24, v24, v72
    v_add_f32 v25, v25, v73
    v_add_f32 v26, v26, v74
    v_add_f32 v27, v27, v75
    v_add_f32 v28, v28, v76
    v_add_f32 v29, v29, v77
    v_add_f32 v30, v30, v78
    v_add_f32 v31, v31, v79
    v_add_f32 v32, v32, v80
    v_add_f32 v33, v33, v81
    v_add_f32 v34, v34, v82
    v_add_f32 v35, v35, v83
    v_add_f32 v36, v36, v84
    v_add_f32 v37, v37, v85
    v_add_f32 v38, v38, v86
    v_add_f32 v39, v39, v87
    s_waitcnt lgkmcnt(0)
    v_add_f32 v24, v24, v88
    v_add_f32 v25, v25, v89
    v_add_f32 v26, v26, v90
    v_add_f32 v27, v27, v91
    v_add_f32 v28, v28, v92
    v_add_f32 v29, v29, v93
    v_add_f32 v30, v30, v94
    v_add_f32 v31, v31, v95
    v_add_f32 v32, v32, v96
    v_add_f32 v33, v33, v97
    v_add_f32 v34, v34, v98
    v_add_f32 v35, v35, v99
    v_add_f32 v36, v36, v100
    v_add_f32 v37, v37, v101
    v_add_f32 v38, v38, v102
    v_add_f32 v39, v39, v103
    v_cvt_pk_bf16_f32 v12, v24, v25
    v_cvt_pk_bf16_f32 v13, v26, v27
    v_cvt_pk_bf16_f32 v14, v28, v29
    v_cvt_pk_bf16_f32 v15, v30, v31
    v_cvt_pk_bf16_f32 v16, v32, v33
    v_cvt_pk_bf16_f32 v17, v34, v35
    v_cvt_pk_bf16_f32 v18, v36, v37
    v_cvt_pk_bf16_f32 v19, v38, v39
    buffer_store_dwordx4 v[12:15], v3, s[8:11], s82 offen sc0 sc1
    buffer_store_dwordx4 v[16:19], v3, s[8:11], s83 offen sc0 sc1
k2_fin:
k2_end:
    s_endpgm
k2_abarO:
    s_cmp_eq_u32 s69, 6
    s_cbranch_scc1 k2_a7O
    ds_write_b32 v4, v139 offset:48
x_L44:
    ds_read_b32 v5, v6
    s_waitcnt lgkmcnt(0)
    v_cmp_ne_u32 vcc, 1, v5
    s_nop 0
    s_cbranch_vccz x_L44x
    s_sleep 2
    s_branch x_L44
x_L44x:
    s_mov_b32 s72, 6
    s_branch k2_abar_rO
k2_a7O:
    v_mov_b32 v5, 96
    ds_read_b32 v5, v5
    ds_write_b32 v4, v139 offset:16
    s_waitcnt lgkmcnt(0)
    v_readfirstlane_b32 s79, v5
    s_branch k2_abar_rO
k2_abarY:
    s_cmp_eq_u32 s69, 6
    s_cbranch_scc1 k2_a7Y
    ds_write_b32 v4, v139 offset:48
x_L45:
    ds_read_b32 v5, v6
    s_waitcnt lgkmcnt(0)
    v_cmp_ne_u32 vcc, 1, v5
    s_nop 0
    s_cbranch_vccz x_L45x
    s_sleep 2
    s_branch x_L45
x_L45x:
    s_mov_b32 s72, 6
    s_branch k2_abar_rY
k2_a7Y:
    v_mov_b32 v5, 96
    ds_read_b32 v5, v5
    ds_write_b32 v4, v139 offset:16
    s_waitcnt lgkmcnt(0)
    v_readfirstlane_b32 s79, v5
    s_branch k2_abar_rY
k2_fb0:
    s_mov_b32 s82, 10485760
    buffer_load_dwordx4 v[24:27], v2, s[20:23], s82 offen sc1
x_L46:
    ds_read_b32 v5, v6
    s_waitcnt lgkmcnt(0)
    v_cmp_ne_u32 vcc, 1, v5
    s_nop 0
    s_cbranch_vccz x_L46x
    s_sleep 2
    s_branch x_L46
x_L46x:
    v_mov_b32 v128, 0xff800000
    v_mov_b32 v130, 0xff800000
    v_mov_b32 v132, v2
    v_add_u32 v133, 1024, v127
    s_mov_b32 s82, 0
    s_waitcnt vmcnt(0)
    s_branch k2_fb1
k2_fb:
    ds_read_b128 v[24:27], v132
k2_fb1:
    ds_read_b32 v28, v133
    v_add_u32 v132, 2560, v132
    v_add_u32 v133, 2560, v133
    s_waitcnt lgkmcnt(0)
    v_mfma_f32_32x32x16_bf16 v[40:55], v[24:27], v[12:15], 0
    v_mfma_f32_32x32x16_bf16 v[56:71], v[24:27], v[16:19], 0
    v_mfma_f32_32x32x8_bf16 v[40:55], v[28:29], v[20:21], v[40:55]
    v_mfma_f32_32x32x8_bf16 v[56:71], v[28:29], v[22:23], v[56:71]
    s_nop 15
    v_max3_f32 v128, v40, v41, v128
    v_max3_f32 v128, v42, v43, v128
    v_max3_f32 v128, v44, v45, v128
    v_max3_f32 v128, v46, v47, v128
    v_max3_f32 v128, v48, v49, v128
    v_max3_f32 v128, v50, v51, v128
    v_max3_f32 v128, v52, v53, v128
    v_max3_f32 v128, v54, v55, v128
    v_max3_f32 v130, v56, v57, v130
    v_max3_f32 v130, v58, v59, v130
    v_max3_f32 v130, v60, v61, v130
    v_max3_f32 v130, v62, v63, v130
    v_max3_f32 v130, v64, v65, v130
    v_max3_f32 v130, v66, v67, v130
    v_max3_f32 v130, v68, v69, v130
    v_max3_f32 v130, v70, v71, v130
    s_add_u32 s82, s82, 1
    s_cmp_lt_u32 s82, 64
    s_cbranch_scc1 k2_fb
    v_mov_b32 v129, v128
    v_mov_b32 v131, v130
    s_nop 1
    v_permlane32_swap_b32 v128, v129
    v_permlane32_swap_b32 v130, v131
    v_max_f32 v128, v128, v129
    v_max_f32 v130, v130, v131
    s_branch k2_shift
.section .rodata,"a"
.p2align 6
.amdhsa_kernel parallel_sum__grouped_kv_mqa__glu_gated_reglu__prompt_kernel
  .amdhsa_next_free_vgpr 168
  .amdhsa_next_free_sgpr 102
  .amdhsa_accum_offset 168
  .amdhsa_group_segment_fixed_size 0
  .amdhsa_kernarg_size 96
  .amdhsa_user_sgpr_count 2
  .amdhsa_user_sgpr_kernarg_segment_ptr 1
  .amdhsa_system_sgpr_workgroup_id_x 1
.end_amdhsa_kernel
```
